```python
import torch

def _softmax(x, axis=-1):
    return torch.softmax(x, dim=axis)
def _gelu(x):
    return torch.nn.functional.gelu(x, approximate="tanh")
def _silu(x):
    return torch.nn.functional.silu(x)
def _sigmoid(x):
    return torch.sigmoid(x)
def _layernorm(x, axis=-1, eps=1e-5):
    m = x.mean(dim=axis, keepdim=True)
    v = x.var(dim=axis, keepdim=True, unbiased=False)
    return (x - m) / torch.sqrt(v + eps)
def _scatter_add(tgt, idx, src, axis=0):
    return tgt.clone().index_add_(axis, idx, src)
def _segment_sum(src, seg, n):
    out = torch.zeros((n,) + src.shape[1:], dtype=src.dtype)
    return out.index_add_(0, seg, src)
def _pad(x, pw):
    flat = tuple(v for pair in reversed(pw) for v in pair)
    return torch.nn.functional.pad(x, flat)

kernel_name = 'standalone__kv_cache_quant_int4_int2_kv_with_per_channel_or_per_token_scales__prompt'

def setup_inputs():

    _w = (lambda a: (lambda t: t.to(torch.bfloat16) if t.is_floating_point() else t)(torch.as_tensor(a)))
    B = 1
    Sq = 2048
    Skv = 2048
    Hq = 32
    Hkv = 4
    Dh = 128
    bits = 4
    G = 128
    if G <= 0 or G >= Skv:
        G = max(1, Skv // 2)
    Skv = (Skv // G) * G
    ngk = Skv // G
    qmax = (1 << bits) - 1
    return {
        "q": _w((lambda *s: torch.randn(*s, dtype=torch.bfloat16) * 1.6)(B, Hq, Sq, Dh)),
        "qk": _w(torch.randint(0, qmax + 1, (B, Hkv, Skv, Dh)).to(torch.int32)),
        "qv": _w(torch.randint(0, qmax + 1, (B, Hkv, Skv, Dh)).to(torch.int32)),
        "k_scales": _w(torch.abs((lambda *s: torch.randn(*s, dtype=torch.bfloat16) * 1.6)(B, Hkv, ngk, Dh)) * 0.05 + 0.02),
        "k_zeros": _w((lambda *s: torch.randn(*s, dtype=torch.bfloat16) * 1.6)(B, Hkv, ngk, Dh) + float(qmax) / 2.0),
        "v_scales": _w(torch.abs((lambda *s: torch.randn(*s, dtype=torch.bfloat16) * 0.05)(B, Hkv, Skv, 1)) * 0.05 + 0.02),
        "v_zeros": _w((lambda *s: torch.randn(*s, dtype=torch.bfloat16) * 0.05)(B, Hkv, Skv, 1) + float(qmax) / 2.0),
    }

def reference(q, qk, qv, k_scales, k_zeros, v_scales, v_zeros):
    B, Hq, Sq, Dh = q.shape
    Hkv, Skv = qk.shape[1], qk.shape[2]
    ngk = k_scales.shape[2]
    G = Skv // ngk
    ks = (lambda x, n, axis: torch.repeat_interleave(x, n, dim=axis))(k_scales, G, axis=2)
    kz = (lambda x, n, axis: torch.repeat_interleave(x, n, dim=axis))(k_zeros, G, axis=2)
    k = ((lambda x, dt: x.to(dt))(qk, q.dtype) - kz) * ks
    v = ((lambda x, dt: x.to(dt))(qv, q.dtype) - v_zeros) * v_scales
    rep = Hq // Hkv
    if rep > 1:
        k = (lambda x, n, axis: torch.repeat_interleave(x, n, dim=axis))(k, rep, axis=1)
        v = (lambda x, n, axis: torch.repeat_interleave(x, n, dim=axis))(v, rep, axis=1)
    scale = float(Dh) ** -0.5
    logits = torch.einsum("bhqd,bhkd->bhqk", q, k) * scale
    p = _softmax(logits, axis=-1)
    o = torch.einsum("bhqk,bhkd->bhqd", p, v)
    return o
```

```asm
; @launch grid=(256,1,1) block=(256,1,1) lds=155904
.amdgcn_target "amdgcn-amd-amdhsa--gfx950"
.text
.globl standalone__kv_cache_quant_int4_int2_kv_with_per_channel_or_per_token_scales__prompt_kernel
.p2align 8
.type standalone__kv_cache_quant_int4_int2_kv_with_per_channel_or_per_token_scales__prompt_kernel,@function
standalone__kv_cache_quant_int4_int2_kv_with_per_channel_or_per_token_scales__prompt_kernel:
    s_cmp_ge_u32 s2, 256
    s_cbranch_scc1 Lm_done
    s_load_dwordx16 s[64:79], s[0:1], 0
    s_load_dwordx4 s[80:83], s[0:1], 64
    s_getpc_b64 s[4:5]
    v_lshlrev_b32 v24, 6, v0
    v_min_u32 v24, Lm_codeend-standalone__kv_cache_quant_int4_int2_kv_with_per_channel_or_per_token_scales__prompt_kernel-64, v24
    global_load_dword v30, v24, s[4:5]
    v_lshrrev_b32 v25, 6, v0
    v_and_b32 v0, 63, v0
    v_readfirstlane_b32 s3, v25
    s_and_b32 s37, s2, 6
    s_lshl_b32 s37, s37, 5
    s_lshr_b32 s33, s2, 3
    s_lshl_b32 s33, s33, 1
    s_add_u32 s37, s37, s33
    s_and_b32 s33, s2, 1
    s_add_u32 s37, s37, s33
    s_mov_b32 s62, s37
    s_mov_b32 s61, 0
    s_min_u32 s39, s3, 1
Lm_prep:
    s_bfe_u32 s16, s62, 0x30003
    s_lshl_b32 s17, s3, 3
    s_add_u32 s16, s16, s17
    s_lshl_b32 s101, s16, 15
    s_lshr_b32 s17, s62, 6
    s_lshl_b32 s17, s17, 5
    s_add_u32 s16, s16, s17
    s_lshl_b32 s97, s16, 15
    v_lshrrev_b32 v64, 4, v0
    v_and_b32 v65, 3, v0
    s_and_b32 s18, s62, 3
    s_bitcmp1_b32 s62, 2
    s_cbranch_scc1 Lm_offv
    v_lshlrev_b32 v66, 1, v64
    v_mov_b32 v67, 0x78
    v_bfe_u32 v66, v67, v66, 2
    v_xor_b32 v66, v66, v65
    v_lshlrev_b32 v24, 4, v66
    v_lshrrev_b32 v67, 2, v0
    v_lshlrev_b32 v67, 9, v67
    v_lshl_add_u32 v27, v66, 5, v67
    s_lshl_b32 s17, s18, 7
    s_add_u32 s97, s97, s17
    s_lshl_b32 s17, s18, 12
    s_add_u32 s101, s101, s17
    s_movk_i32 s94, 16384
    s_movk_i32 s95, 8192
    s_movk_i32 s96, 16
    s_lshr_b32 s16, s16, 1
    s_lshl_b32 s16, s16, 2
    s_add_u32 s16, s16, s18
    s_lshl_b32 s16, s16, 6
    s_mov_b32 s17, s16
    s_branch Lm_offdone
Lm_offv:
    v_lshlrev_b32 v24, 3, v64
    v_and_b32 v65, 15, v0
    v_lshlrev_b32 v65, 4, v65
    v_lshl_add_u32 v27, v64, 11, v65
    s_lshr_b32 s33, s18, 1
    s_and_b32 s34, s18, 1
    s_lshl_b32 s17, s33, 6
    s_add_u32 s17, s17, s34
    s_lshl_b32 s17, s17, 8
    s_add_u32 s97, s97, s17
    s_lshl_b32 s17, s34, 3
    s_add_u32 s17, s17, s33
    s_add_u32 s17, s17, 16
    s_lshl_b32 s17, s17, 10
    s_add_u32 s101, s101, s17
    s_movk_i32 s94, 8192
    s_movk_i32 s95, 1024
    s_movk_i32 s96, 512
    s_lshl_b32 s16, s16, 1
    s_add_u32 s16, s16, s33
    s_lshl_b32 s16, s16, 6
    s_add_u32 s17, s16, 32
Lm_offdone:
    s_mov_b32 s22, 0x400000
    s_mov_b32 s23, 0x20000
    s_mov_b32 s26, 0x4000
    s_mov_b32 s27, 0x20000
    s_mov_b32 s30, 0x4000
    s_mov_b32 s31, 0x20000
    s_bitcmp1_b32 s62, 2
    s_waitcnt lgkmcnt(0)
    s_cselect_b64 s[24:25], s[74:75], s[70:71]
    s_cselect_b64 s[28:29], s[74:75], s[72:73]
    s_cselect_b64 s[20:21], s[68:69], s[66:67]
    s_and_b32 s25, s25, 0xffff
    s_and_b32 s29, s29, 0xffff
    s_and_b32 s21, s21, 0xffff
    buffer_load_dwordx4 v[64:67], v24, s[24:27], s16 offen
    buffer_load_dwordx4 v[68:71], v24, s[28:31], s17 offen
    s_and_b32 s0, s62, 4
    s_cmp_lg_u32 s39, 0
    s_cbranch_scc1 Lm_nocodes
    s_mov_b32 s16, s97
    buffer_load_dwordx4 v[8:11], v27, s[20:23], s16 offen
    s_add_u32 s17, s16, s96
    buffer_load_dwordx4 v[12:15], v27, s[20:23], s17 offen
    s_add_u32 s17, s16, s95
    buffer_load_dwordx4 v[16:19], v27, s[20:23], s17 offen
    s_add_u32 s17, s17, s96
    buffer_load_dwordx4 v[20:23], v27, s[20:23], s17 offen
    s_add_u32 s16, s16, s94
    buffer_load_dwordx4 v[112:115], v27, s[20:23], s16 offen
    s_add_u32 s17, s16, s96
    buffer_load_dwordx4 v[116:119], v27, s[20:23], s17 offen
    s_add_u32 s17, s16, s95
    buffer_load_dwordx4 v[120:123], v27, s[20:23], s17 offen
    s_add_u32 s17, s17, s96
    buffer_load_dwordx4 v[124:127], v27, s[20:23], s17 offen
Lm_nocodes:
    s_mov_b32 s24, s74
    s_and_b32 s25, s75, 0xffff
    s_mov_b32 s26, 0x4000
    s_mov_b32 s27, 0x20000
    s_mov_b32 s28, s76
    s_and_b32 s29, s77, 0xffff
    s_mov_b32 s30, 0x4000
    s_mov_b32 s31, 0x20000
    v_lshrrev_b32 v24, 2, v0
    v_and_b32 v25, 3, v0
    v_lshlrev_b32 v25, 3, v25
    v_lshl_add_u32 v25, v24, 6, v25
    s_and_b32 s33, s37, 0xc0
    s_lshl_b32 s16, s33, 6
    s_lshl_b32 s17, s3, 10
    s_add_u32 s16, s16, s17
    buffer_load_dwordx2 v[72:73], v25, s[24:27], s16 offen
    buffer_load_dwordx2 v[74:75], v25, s[24:27], s16 offen offset:32
    buffer_load_dwordx2 v[76:77], v25, s[28:31], s16 offen
    buffer_load_dwordx2 v[78:79], v25, s[28:31], s16 offen offset:32
    s_mov_b32 s4, s64
    s_and_b32 s5, s65, 0xffff
    s_mov_b32 s6, 0x1000000
    s_mov_b32 s7, 0x20000
    v_lshrrev_b32 v24, 4, v0
    v_and_b32 v25, 15, v0
    v_xor_b32 v6, v25, v24
    v_lshlrev_b32 v6, 4, v6
    v_lshl_add_u32 v92, v24, 8, v6
    v_xor_b32 v93, 64, v92
    v_xor_b32 v94, 128, v92
    v_xor_b32 v95, 192, v92
    s_lshl_b32 s32, s37, 16
    s_lshl_b32 s17, s3, 14
    s_add_u32 s32, s32, s17
    s_lshl_b32 s19, s3, 13
    s_cmp_eq_u32 s39, 0
    s_cbranch_scc1 Lm_noq
    s_add_u32 m0, s19, 65536
    s_add_u32 s34, s32, 0
    buffer_load_dwordx4 v92, s[4:7], s34 offen offset:0 lds
    buffer_load_dwordx4 v93, s[4:7], s34 offen offset:1024 lds
    buffer_load_dwordx4 v94, s[4:7], s34 offen offset:2048 lds
    buffer_load_dwordx4 v95, s[4:7], s34 offen offset:3072 lds
Lm_noq:
    s_cmp_lg_u32 s61, 0
    s_cbranch_scc1 Lm_havekv
    s_lshl_b32 s17, s33, 1
    s_add_u32 s17, s17, 4325376
    s_load_dword s98, s[82:83], s17
    s_lshl_b32 s33, s33, 14
    s_add_u32 s8, s82, s33
    s_addc_u32 s9, s83, 0
    s_and_b32 s9, s9, 0xffff
    s_mov_b32 s10, 0x100000
    s_mov_b32 s11, 0x20000
    s_add_u32 s63, s37, 1
    s_mov_b32 s35, 0
    s_mov_b32 s100, 0
    v_lshlrev_b32 v1, 4, v0
    v_add_u32 v2, 4096, v1
    v_bfe_u32 v6, v0, 2, 2
    v_lshlrev_b32 v6, 1, v6
    v_mov_b32 v31, 0x78
    v_bfe_u32 v6, v31, v6, 2
    v_xor_b32 v6, v6, v24
    v_lshl_add_u32 v6, v25, 2, v6
    v_lshlrev_b32 v31, 4, v6
Lm_havekv:
    v_mov_b32 v88, 0
    v_mov_b32 v89, 0
    v_mov_b32 v90, 0
    v_mov_b32 v91, 0
    s_mov_b32 s92, 0
    s_cmp_lg_u32 s0, 0
    v_mfma_f32_32x32x16_bf16 v[128:143], v[88:91], v[88:91], 0
    v_mfma_f32_32x32x16_bf16 v[144:159], v[88:91], v[88:91], 0
    v_mfma_f32_32x32x16_bf16 v[160:175], v[88:91], v[88:91], 0
    v_mfma_f32_32x32x16_bf16 v[176:191], v[88:91], v[88:91], 0
    v_mfma_f32_32x32x16_bf16 v[192:207], v[88:91], v[88:91], 0
    v_mfma_f32_32x32x16_bf16 v[208:223], v[88:91], v[88:91], 0
    v_mfma_f32_32x32x16_bf16 v[224:239], v[88:91], v[88:91], 0
    v_mfma_f32_32x32x16_bf16 v[240:255], v[88:91], v[88:91], 0
    s_waitcnt vmcnt(8)
    s_cbranch_scc1 Lm_prepv
    s_mov_b32 s17, 0x3e0293ee
    v_lshlrev_b32 v96, 16, v64
    v_and_b32 v97, 0xffff0000, v64
    v_lshlrev_b32 v98, 16, v65
    v_and_b32 v99, 0xffff0000, v65
    v_lshlrev_b32 v100, 16, v66
    v_and_b32 v101, 0xffff0000, v66
    v_lshlrev_b32 v102, 16, v67
    v_and_b32 v103, 0xffff0000, v67
    v_lshlrev_b32 v104, 16, v68
    v_and_b32 v105, 0xffff0000, v68
    v_lshlrev_b32 v106, 16, v69
    v_and_b32 v107, 0xffff0000, v69
    v_lshlrev_b32 v108, 16, v70
    v_and_b32 v109, 0xffff0000, v70
    v_lshlrev_b32 v110, 16, v71
    v_and_b32 v111, 0xffff0000, v71
    v_mul_f32 v96, s17, v96
    v_mul_f32 v97, s17, v97
    v_mul_f32 v98, s17, v98
    v_mul_f32 v99, s17, v99
    v_mul_f32 v100, s17, v100
    v_mul_f32 v101, s17, v101
    v_mul_f32 v102, s17, v102
    v_mul_f32 v103, s17, v103
    v_mul_f32 v104, -v104, v96
    v_mul_f32 v105, -v105, v97
    v_mul_f32 v106, -v106, v98
    v_mul_f32 v107, -v107, v99
    v_mul_f32 v108, -v108, v100
    v_mul_f32 v109, -v109, v101
    v_mul_f32 v110, -v110, v102
    v_mul_f32 v111, -v111, v103
    s_cmp_lg_u32 s39, 0
    s_cbranch_scc1 Lm_prepdone
Lm_cvtk:
    s_waitcnt vmcnt(10)
    v_cvt_f32_i32 v8, v8
    v_cvt_f32_i32 v9, v9
    v_cvt_f32_i32 v10, v10
    v_cvt_f32_i32 v11, v11
    v_cvt_f32_i32 v12, v12
    v_cvt_f32_i32 v13, v13
    v_cvt_f32_i32 v14, v14
    v_cvt_f32_i32 v15, v15
    v_pk_fma_f32 v[8:9], v[8:9], v[96:97], v[104:105]
    v_pk_fma_f32 v[10:11], v[10:11], v[98:99], v[106:107]
    v_pk_fma_f32 v[12:13], v[12:13], v[100:101], v[108:109]
    v_pk_fma_f32 v[14:15], v[14:15], v[102:103], v[110:111]
    v_cvt_pk_bf16_f32 v8, v8, v9
    v_cvt_pk_bf16_f32 v9, v10, v11
    v_cvt_pk_bf16_f32 v10, v12, v13
    v_cvt_pk_bf16_f32 v11, v14, v15
    buffer_store_dwordx4 v[8:11], v1, s[8:11], s101 offen offset:0 sc1
    s_waitcnt vmcnt(9)
    v_cvt_f32_i32 v16, v16
    v_cvt_f32_i32 v17, v17
    v_cvt_f32_i32 v18, v18
    v_cvt_f32_i32 v19, v19
    v_cvt_f32_i32 v20, v20
    v_cvt_f32_i32 v21, v21
    v_cvt_f32_i32 v22, v22
    v_cvt_f32_i32 v23, v23
    v_pk_fma_f32 v[16:17], v[16:17], v[96:97], v[104:105]
    v_pk_fma_f32 v[18:19], v[18:19], v[98:99], v[106:107]
    v_pk_fma_f32 v[20:21], v[20:21], v[100:101], v[108:109]
    v_pk_fma_f32 v[22:23], v[22:23], v[102:103], v[110:111]
    v_cvt_pk_bf16_f32 v16, v16, v17
    v_cvt_pk_bf16_f32 v17, v18, v19
    v_cvt_pk_bf16_f32 v18, v20, v21
    v_cvt_pk_bf16_f32 v19, v22, v23
    buffer_store_dwordx4 v[16:19], v1, s[8:11], s101 offen offset:1024 sc1
    s_waitcnt vmcnt(8)
    v_cvt_f32_i32 v112, v112
    v_cvt_f32_i32 v113, v113
    v_cvt_f32_i32 v114, v114
    v_cvt_f32_i32 v115, v115
    v_cvt_f32_i32 v116, v116
    v_cvt_f32_i32 v117, v117
    v_cvt_f32_i32 v118, v118
    v_cvt_f32_i32 v119, v119
    v_pk_fma_f32 v[112:113], v[112:113], v[96:97], v[104:105]
    v_pk_fma_f32 v[114:115], v[114:115], v[98:99], v[106:107]
    v_pk_fma_f32 v[116:117], v[116:117], v[100:101], v[108:109]
    v_pk_fma_f32 v[118:119], v[118:119], v[102:103], v[110:111]
    v_cvt_pk_bf16_f32 v112, v112, v113
    v_cvt_pk_bf16_f32 v113, v114, v115
    v_cvt_pk_bf16_f32 v114, v116, v117
    v_cvt_pk_bf16_f32 v115, v118, v119
    buffer_store_dwordx4 v[112:115], v1, s[8:11], s101 offen offset:2048 sc1
    s_waitcnt vmcnt(7)
    v_cvt_f32_i32 v120, v120
    v_cvt_f32_i32 v121, v121
    v_cvt_f32_i32 v122, v122
    v_cvt_f32_i32 v123, v123
    v_cvt_f32_i32 v124, v124
    v_cvt_f32_i32 v125, v125
    v_cvt_f32_i32 v126, v126
    v_cvt_f32_i32 v127, v127
    v_pk_fma_f32 v[120:121], v[120:121], v[96:97], v[104:105]
    v_pk_fma_f32 v[122:123], v[122:123], v[98:99], v[106:107]
    v_pk_fma_f32 v[124:125], v[124:125], v[100:101], v[108:109]
    v_pk_fma_f32 v[126:127], v[126:127], v[102:103], v[110:111]
    v_cvt_pk_bf16_f32 v120, v120, v121
    v_cvt_pk_bf16_f32 v121, v122, v123
    v_cvt_pk_bf16_f32 v122, v124, v125
    v_cvt_pk_bf16_f32 v123, v126, v127
    buffer_store_dwordx4 v[120:123], v1, s[8:11], s101 offen offset:3072 sc1
    s_cmp_lg_u32 s92, 0
    s_cbranch_scc1 Lm_hook_cvtd
    s_branch Lm_cvtdone
    s_nop 0
    s_nop 0
    s_nop 0
    s_nop 0
    s_nop 0
    s_nop 0
    s_nop 0
    s_nop 0
    s_nop 0
    s_nop 0
    s_nop 0
    s_nop 0
    s_nop 0
Lm_prepv:
    v_lshlrev_b32 v96, 16, v64
    v_and_b32 v97, 0xffff0000, v64
    v_lshlrev_b32 v98, 16, v65
    v_and_b32 v99, 0xffff0000, v65
    v_lshlrev_b32 v100, 16, v68
    v_and_b32 v101, 0xffff0000, v68
    v_lshlrev_b32 v102, 16, v69
    v_and_b32 v103, 0xffff0000, v69
    v_and_b32 v96, 0xff800000, v96
    v_and_b32 v97, 0xff800000, v97
    v_and_b32 v98, 0xff800000, v98
    v_and_b32 v99, 0xff800000, v99
    v_and_b32 v100, 0xff800000, v100
    v_and_b32 v101, 0xff800000, v101
    v_and_b32 v102, 0xff800000, v102
    v_and_b32 v103, 0xff800000, v103
    v_mul_f32 v104, 0x41800000, v96
    v_mul_f32 v105, 0x41800000, v97
    v_mul_f32 v106, 0x41800000, v98
    v_mul_f32 v107, 0x41800000, v99
    v_mul_f32 v108, 0x41800000, v100
    v_mul_f32 v109, 0x41800000, v101
    v_mul_f32 v110, 0x41800000, v102
    v_mul_f32 v111, 0x41800000, v103
    s_cmp_lg_u32 s39, 0
    s_cbranch_scc1 Lm_prepdone
Lm_cvtv:
    s_waitcnt vmcnt(11)
    v_cvt_f32_i32 v8, v8
    v_cvt_f32_i32 v9, v9
    v_cvt_f32_i32 v10, v10
    v_cvt_f32_i32 v11, v11
    v_pk_fma_f32 v[8:9], v[8:9], v[96:97], v[104:105] op_sel:[0,0,0] op_sel_hi:[1,0,0]
    v_pk_fma_f32 v[10:11], v[10:11], v[96:97], v[104:105] op_sel:[0,0,0] op_sel_hi:[1,0,0]
    s_waitcnt vmcnt(10)
    v_cvt_f32_i32 v12, v12
    v_cvt_f32_i32 v13, v13
    v_cvt_f32_i32 v14, v14
    v_cvt_f32_i32 v15, v15
    v_pk_fma_f32 v[12:13], v[12:13], v[96:97], v[104:105] op_sel:[0,1,1] op_sel_hi:[1,1,1]
    v_pk_fma_f32 v[14:15], v[14:15], v[96:97], v[104:105] op_sel:[0,1,1] op_sel_hi:[1,1,1]
    s_waitcnt vmcnt(9)
    v_cvt_f32_i32 v16, v16
    v_cvt_f32_i32 v17, v17
    v_cvt_f32_i32 v18, v18
    v_cvt_f32_i32 v19, v19
    v_pk_fma_f32 v[16:17], v[16:17], v[98:99], v[106:107] op_sel:[0,0,0] op_sel_hi:[1,0,0]
    v_pk_fma_f32 v[18:19], v[18:19], v[98:99], v[106:107] op_sel:[0,0,0] op_sel_hi:[1,0,0]
    s_waitcnt vmcnt(8)
    v_cvt_f32_i32 v20, v20
    v_cvt_f32_i32 v21, v21
    v_cvt_f32_i32 v22, v22
    v_cvt_f32_i32 v23, v23
    v_pk_fma_f32 v[20:21], v[20:21], v[98:99], v[106:107] op_sel:[0,1,1] op_sel_hi:[1,1,1]
    v_pk_fma_f32 v[22:23], v[22:23], v[98:99], v[106:107] op_sel:[0,1,1] op_sel_hi:[1,1,1]
    s_waitcnt vmcnt(7)
    v_cvt_f32_i32 v112, v112
    v_cvt_f32_i32 v113, v113
    v_cvt_f32_i32 v114, v114
    v_cvt_f32_i32 v115, v115
    v_pk_fma_f32 v[112:113], v[112:113], v[100:101], v[108:109] op_sel:[0,0,0] op_sel_hi:[1,0,0]
    v_pk_fma_f32 v[114:115], v[114:115], v[100:101], v[108:109] op_sel:[0,0,0] op_sel_hi:[1,0,0]
    s_waitcnt vmcnt(6)
    v_cvt_f32_i32 v116, v116
    v_cvt_f32_i32 v117, v117
    v_cvt_f32_i32 v118, v118
    v_cvt_f32_i32 v119, v119
    v_pk_fma_f32 v[116:117], v[116:117], v[100:101], v[108:109] op_sel:[0,1,1] op_sel_hi:[1,1,1]
    v_pk_fma_f32 v[118:119], v[118:119], v[100:101], v[108:109] op_sel:[0,1,1] op_sel_hi:[1,1,1]
    s_waitcnt vmcnt(5)
    v_cvt_f32_i32 v120, v120
    v_cvt_f32_i32 v121, v121
    v_cvt_f32_i32 v122, v122
    v_cvt_f32_i32 v123, v123
    v_pk_fma_f32 v[120:121], v[120:121], v[102:103], v[110:111] op_sel:[0,0,0] op_sel_hi:[1,0,0]
    v_pk_fma_f32 v[122:123], v[122:123], v[102:103], v[110:111] op_sel:[0,0,0] op_sel_hi:[1,0,0]
    s_waitcnt vmcnt(4)
    v_cvt_f32_i32 v124, v124
    v_cvt_f32_i32 v125, v125
    v_cvt_f32_i32 v126, v126
    v_cvt_f32_i32 v127, v127
    v_pk_fma_f32 v[124:125], v[124:125], v[102:103], v[110:111] op_sel:[0,1,1] op_sel_hi:[1,1,1]
    v_pk_fma_f32 v[126:127], v[126:127], v[102:103], v[110:111] op_sel:[0,1,1] op_sel_hi:[1,1,1]
    v_cvt_pk_bf16_f32 v96, v8, v12
    v_cvt_pk_bf16_f32 v97, v16, v20
    v_cvt_pk_bf16_f32 v98, v112, v116
    v_cvt_pk_bf16_f32 v99, v120, v124
    buffer_store_dwordx4 v[96:99], v1, s[8:11], s101 offen offset:0 sc1
    v_cvt_pk_bf16_f32 v100, v9, v13
    v_cvt_pk_bf16_f32 v101, v17, v21
    v_cvt_pk_bf16_f32 v102, v113, v117
    v_cvt_pk_bf16_f32 v103, v121, v125
    buffer_store_dwordx4 v[100:103], v1, s[8:11], s101 offen offset:2048 sc1
    v_cvt_pk_bf16_f32 v104, v10, v14
    v_cvt_pk_bf16_f32 v105, v18, v22
    v_cvt_pk_bf16_f32 v106, v114, v118
    v_cvt_pk_bf16_f32 v107, v122, v126
    buffer_store_dwordx4 v[104:107], v2, s[8:11], s101 offen offset:0 sc1
    v_cvt_pk_bf16_f32 v108, v11, v15
    v_cvt_pk_bf16_f32 v109, v19, v23
    v_cvt_pk_bf16_f32 v110, v115, v119
    v_cvt_pk_bf16_f32 v111, v123, v127
    buffer_store_dwordx4 v[108:111], v2, s[8:11], s101 offen offset:2048 sc1
Lm_cvtdone:
    s_cmp_lg_u32 s92, 0
    s_cbranch_scc1 Lm_hook_cvtd
    s_add_u32 s62, s62, 1
    s_cmp_lt_u32 s62, s63
    s_cbranch_scc1 Lm_prep
Lm_prepdone:
    s_and_b32 s16, s37, 0xc0
    s_lshl_b32 s16, s16, 8
    s_add_u32 s16, s16, 4194304
    s_add_u32 s84, s82, s16
    s_addc_u32 s85, s83, 0
    s_and_b32 s85, s85, 0xffff
    s_mov_b32 s86, 0x4000
    s_mov_b32 s87, 0x20000
    s_and_b32 s16, s37, 63
    s_lshl_b32 s16, s16, 7
    s_waitcnt lgkmcnt(0)
    s_mul_i32 s99, s98, 0x9e3779b1
    s_add_u32 s99, s99, 0x85ebca6b
    s_or_b32 s17, s3, s61
    s_cselect_b32 s86, 0, 0x4000
    s_cselect_b32 s17, 0, s99
    s_mov_b32 s1, 2
    v_mov_b32 v28, s17
    s_cmp_lg_u32 s39, 0
    s_cbranch_scc1 Lm_late
    s_add_u32 m0, s19, 65536
    s_add_u32 s34, s32, 0
    buffer_load_dwordx4 v92, s[4:7], s34 offen offset:0 lds
    buffer_load_dwordx4 v93, s[4:7], s34 offen offset:1024 lds
    buffer_load_dwordx4 v94, s[4:7], s34 offen offset:2048 lds
    buffer_load_dwordx4 v95, s[4:7], s34 offen offset:3072 lds
    s_mov_b32 s22, 0
    s_mov_b64 exec, 1
    s_waitcnt vmcnt(4)
    buffer_store_dword v28, off, s[84:87], s16 sc1
    s_mov_b64 exec, -1
    s_add_u32 m0, s19, 69632
    s_add_u32 s34, s32, 4096
    buffer_load_dwordx4 v92, s[4:7], s34 offen offset:0 lds
    buffer_load_dwordx4 v93, s[4:7], s34 offen offset:1024 lds
    buffer_load_dwordx4 v94, s[4:7], s34 offen offset:2048 lds
    buffer_load_dwordx4 v95, s[4:7], s34 offen offset:3072 lds
    s_branch Lm_aux
Lm_late:
    s_waitcnt vmcnt(4)
    s_add_u32 m0, s19, 69632
    s_add_u32 s34, s32, 4096
    buffer_load_dwordx4 v92, s[4:7], s34 offen offset:0 lds
    buffer_load_dwordx4 v93, s[4:7], s34 offen offset:1024 lds
    buffer_load_dwordx4 v94, s[4:7], s34 offen offset:2048 lds
    buffer_load_dwordx4 v95, s[4:7], s34 offen offset:3072 lds
Lm_aux:
    v_lshlrev_b32 v32, 16, v72
    v_and_b32 v33, 0xffff0000, v72
    v_lshlrev_b32 v34, 16, v73
    v_and_b32 v35, 0xffff0000, v73
    v_lshlrev_b32 v36, 16, v74
    v_and_b32 v37, 0xffff0000, v74
    v_lshlrev_b32 v38, 16, v75
    v_and_b32 v39, 0xffff0000, v75
    v_lshlrev_b32 v40, 16, v76
    v_and_b32 v41, 0xffff0000, v76
    v_lshlrev_b32 v42, 16, v77
    v_and_b32 v43, 0xffff0000, v77
    v_lshlrev_b32 v44, 16, v78
    v_and_b32 v45, 0xffff0000, v78
    v_lshlrev_b32 v46, 16, v79
    v_and_b32 v47, 0xffff0000, v79
    s_mov_b32 s33, 0x007fffff
    v_and_b32 v48, 0xff800000, v32
    v_add_f32 v40, 0x41800000, v40
    v_and_or_b32 v32, v32, s33, 1.0
    v_and_b32 v49, 0xff800000, v33
    v_add_f32 v41, 0x41800000, v41
    v_and_or_b32 v33, v33, s33, 1.0
    v_and_b32 v50, 0xff800000, v34
    v_add_f32 v42, 0x41800000, v42
    v_and_or_b32 v34, v34, s33, 1.0
    v_and_b32 v51, 0xff800000, v35
    v_add_f32 v43, 0x41800000, v43
    v_and_or_b32 v35, v35, s33, 1.0
    v_and_b32 v52, 0xff800000, v36
    v_add_f32 v44, 0x41800000, v44
    v_and_or_b32 v36, v36, s33, 1.0
    v_and_b32 v53, 0xff800000, v37
    v_add_f32 v45, 0x41800000, v45
    v_and_or_b32 v37, v37, s33, 1.0
    v_and_b32 v54, 0xff800000, v38
    v_add_f32 v46, 0x41800000, v46
    v_and_or_b32 v38, v38, s33, 1.0
    v_and_b32 v55, 0xff800000, v39
    v_add_f32 v47, 0x41800000, v47
    v_and_or_b32 v39, v39, s33, 1.0
    v_mul_f32 v40, v40, v48
    v_log_f32 v56, v32
    v_rcp_f32 v32, v32
    v_mul_f32 v41, v41, v49
    v_log_f32 v57, v33
    v_rcp_f32 v33, v33
    v_mul_f32 v42, v42, v50
    v_log_f32 v58, v34
    v_rcp_f32 v34, v34
    v_mul_f32 v43, v43, v51
    v_log_f32 v59, v35
    v_rcp_f32 v35, v35
    v_mul_f32 v44, v44, v52
    v_log_f32 v60, v36
    v_rcp_f32 v36, v36
    v_mul_f32 v45, v45, v53
    v_log_f32 v61, v37
    v_rcp_f32 v37, v37
    v_mul_f32 v46, v46, v54
    v_log_f32 v62, v38
    v_rcp_f32 v38, v38
    v_mul_f32 v47, v47, v55
    v_log_f32 v63, v39
    v_rcp_f32 v39, v39
    v_add_f32 v56, 0xc0b00000, v56
    v_add_f32 v57, 0xc0b00000, v57
    v_add_f32 v58, 0xc0b00000, v58
    v_add_f32 v59, 0xc0b00000, v59
    v_add_f32 v60, 0xc0b00000, v60
    v_add_f32 v61, 0xc0b00000, v61
    v_add_f32 v62, 0xc0b00000, v62
    v_add_f32 v63, 0xc0b00000, v63
    v_lshrrev_b32 v24, 2, v0
    v_and_b32 v25, 3, v0
    s_lshl_b32 s33, s3, 11
    s_add_u32 s33, s33, 131072
    v_lshlrev_b32 v25, 4, v25
    v_lshl_add_u32 v25, v24, 7, v25
    v_add_u32 v25, s33, v25
    ds_write_b128 v25, v[56:59]
    ds_write_b128 v25, v[60:63] offset:64
    s_lshl_b32 s33, s3, 12
    s_add_u32 s33, s33, 139264
    v_lshrrev_b32 v24, 1, v0
    v_and_b32 v6, 1, v0
    v_lshlrev_b32 v6, 3, v6
    v_lshl_add_u32 v6, v24, 7, v6
    v_and_b32 v24, 3, v24
    v_lshl_add_u32 v6, v24, 4, v6
    v_add_u32 v6, s33, v6
    v_cvt_pk_bf16_f32 v80, v32, v33
    v_cvt_pk_bf16_f32 v82, v34, v35
    v_cvt_pk_bf16_f32 v81, v36, v37
    v_cvt_pk_bf16_f32 v83, v38, v39
    v_lshlrev_b32 v48, 16, v80
    v_and_b32 v49, 0xffff0000, v80
    v_lshlrev_b32 v50, 16, v82
    v_and_b32 v51, 0xffff0000, v82
    v_lshlrev_b32 v52, 16, v81
    v_and_b32 v53, 0xffff0000, v81
    v_lshlrev_b32 v54, 16, v83
    v_and_b32 v55, 0xffff0000, v83
    v_xor_b32 v24, 0, v6
    v_xor_b32 v25, 16, v6
    ds_write2_b64 v24, v[80:81], v[82:83] offset0:0 offset1:8
    v_sub_f32 v48, v32, v48
    v_sub_f32 v49, v33, v49
    v_sub_f32 v50, v34, v50
    v_sub_f32 v51, v35, v51
    v_sub_f32 v52, v36, v52
    v_sub_f32 v53, v37, v53
    v_sub_f32 v54, v38, v54
    v_sub_f32 v55, v39, v55
    v_cvt_pk_bf16_f32 v84, v48, v49
    v_cvt_pk_bf16_f32 v86, v50, v51
    v_cvt_pk_bf16_f32 v85, v52, v53
    v_cvt_pk_bf16_f32 v87, v54, v55
    ds_write2_b64 v25, v[84:85], v[86:87] offset0:0 offset1:8
    s_waitcnt lgkmcnt(0)
    v_cvt_pk_bf16_f32 v80, v40, v41
    v_cvt_pk_bf16_f32 v82, v42, v43
    v_cvt_pk_bf16_f32 v81, v44, v45
    v_cvt_pk_bf16_f32 v83, v46, v47
    v_lshlrev_b32 v48, 16, v80
    v_and_b32 v49, 0xffff0000, v80
    v_lshlrev_b32 v50, 16, v82
    v_and_b32 v51, 0xffff0000, v82
    v_lshlrev_b32 v52, 16, v81
    v_and_b32 v53, 0xffff0000, v81
    v_lshlrev_b32 v54, 16, v83
    v_and_b32 v55, 0xffff0000, v83
    v_xor_b32 v24, 32, v6
    v_xor_b32 v25, 48, v6
    ds_write2_b64 v24, v[80:81], v[82:83] offset0:0 offset1:8
    v_sub_f32 v48, v40, v48
    v_sub_f32 v49, v41, v49
    v_sub_f32 v50, v42, v50
    v_sub_f32 v51, v43, v51
    v_sub_f32 v52, v44, v52
    v_sub_f32 v53, v45, v53
    v_sub_f32 v54, v46, v54
    v_sub_f32 v55, v47, v55
    v_cvt_pk_bf16_f32 v84, v48, v49
    v_cvt_pk_bf16_f32 v86, v50, v51
    v_cvt_pk_bf16_f32 v85, v52, v53
    v_cvt_pk_bf16_f32 v87, v54, v55
    ds_write2_b64 v25, v[84:85], v[86:87] offset0:0 offset1:8
    v_min_u32 v29, 23, v0
    v_lshlrev_b32 v29, 7, v29
    s_mov_b32 s12, s78
    s_and_b32 s13, s79, 0xffff
    s_mov_b32 s14, 0x1000000
    s_mov_b32 s15, 0x20000
    s_mov_b32 s24, s97
    s_add_u32 s25, s97, s96
    s_add_u32 s26, s97, s95
    s_add_u32 s27, s26, s96
    s_add_u32 s28, s24, s94
    s_add_u32 s29, s25, s94
    s_add_u32 s30, s26, s94
    s_add_u32 s31, s27, s94
    s_mov_b32 s94, 0
    s_lshl_b32 s95, s3, 2
    s_add_u32 s95, s95, s16
    s_add_u32 s95, s95, 8188
    v_and_b32 v64, 15, v0
    v_lshrrev_b32 v65, 4, v0
    v_lshlrev_b32 v66, 8, v64
    s_add_u32 s34, s19, 0x10000
    v_add_u32 v66, s34, v66
    v_xor_b32 v67, v65, v64
    v_lshl_add_u32 v8, v67, 4, v66
    v_xor_b32 v9, 64, v8
    v_xor_b32 v10, 128, v8
    v_xor_b32 v11, 192, v8
    v_mfma_f32_32x32x16_bf16 v[48:63], v[88:91], v[88:91], 0
    v_lshlrev_b32 v67, 1, v65
    v_xor_b32 v67, v67, v64
    v_lshl_add_u32 v68, v67, 4, v66
    v_xor_b32 v69, 16, v68
    v_xor_b32 v70, 128, v68
    v_xor_b32 v71, 144, v68
    v_add_u32 v72, s34, v1
    v_accvgpr_write_b32 a196, v68
    v_accvgpr_write_b32 a200, v92
    v_accvgpr_write_b32 a197, v69
    v_accvgpr_write_b32 a201, v93
    v_accvgpr_write_b32 a198, v70
    v_accvgpr_write_b32 a202, v94
    v_accvgpr_write_b32 a199, v71
    v_accvgpr_write_b32 a203, v95
    v_accvgpr_write_b32 a204, v72
    v_mov_b32 v3, v1
    v_mov_b32 v4, v31
    v_lshlrev_b32 v5, 4, v65
    v_add_u32 v5, 131072, v5
    v_and_b32 v66, 3, v0
    v_xor_b32 v66, v66, v65
    v_lshrrev_b32 v67, 3, v0
    v_lshl_add_u32 v66, v67, 2, v66
    v_lshlrev_b32 v7, 4, v66
    v_add_u32 v7, 139264, v7
    v_and_b32 v67, 1, v67
    v_mul_u32_u24 v26, 0xaaaa, v67
    v_add_u32 v26, 0x4444, v26
    buffer_load_dword v30, v29, s[84:87], 0 offen sc1
    s_waitcnt vmcnt(3)
    s_add_u32 m0, s19, 98304
    s_add_u32 s34, s32, 8192
    buffer_load_dwordx4 v92, s[4:7], s34 offen offset:0 lds
    buffer_load_dwordx4 v93, s[4:7], s34 offen offset:1024 lds
    buffer_load_dwordx4 v94, s[4:7], s34 offen offset:2048 lds
    buffer_load_dwordx4 v95, s[4:7], s34 offen offset:3072 lds
    s_waitcnt vmcnt(4) lgkmcnt(0)
    ds_read_b128 a[0:3], v8 offset:0
    ds_read_b128 a[4:7], v9 offset:0
    ds_read_b128 a[8:11], v10 offset:0
    ds_read_b128 a[12:15], v11 offset:0
    ds_read_b128 a[16:19], v8 offset:4096
    ds_read_b128 a[20:23], v9 offset:4096
    ds_read_b128 a[24:27], v10 offset:4096
    ds_read_b128 a[28:31], v11 offset:4096
    v_cmp_ne_u32 vcc, v30, v28
    s_cbranch_vccz Lm_got
Lm_poll:
    buffer_load_dword v30, v29, s[84:87], 0 offen sc1
    s_add_u32 s94, s94, 1
    s_waitcnt vmcnt(0)
    v_cmp_ne_u32 vcc, v30, v28
    s_cbranch_vccz Lm_got
    s_cmp_lt_u32 s94, 4096
    s_cbranch_scc1 Lm_poll
    s_mov_b32 s100, 2
Lm_got:
    s_lshl_b32 s16, s3, 12
    s_mov_b32 m0, s16
    s_barrier
    buffer_load_dwordx4 v1, s[8:11], s16 offen offset:0 sc1 lds
    buffer_load_dwordx4 v1, s[8:11], s16 offen offset:1024 sc1 lds
    buffer_load_dwordx4 v1, s[8:11], s16 offen offset:2048 sc1 lds
    buffer_load_dwordx4 v1, s[8:11], s16 offen offset:3072 sc1 lds
    s_add_u32 s16, s16, 0x4000
    s_mov_b32 m0, s16
    ds_read_b128 v[32:35], v5 offset:0
    ds_read_b128 v[36:39], v5 offset:64
    ds_read_b128 v[40:43], v5 offset:128
    ds_read_b128 v[44:47], v5 offset:192
    buffer_load_dwordx4 v1, s[8:11], s16 offen offset:0 sc1 lds
    buffer_load_dwordx4 v1, s[8:11], s16 offen offset:1024 sc1 lds
    buffer_load_dwordx4 v1, s[8:11], s16 offen offset:2048 sc1 lds
    buffer_load_dwordx4 v1, s[8:11], s16 offen offset:3072 sc1 lds
    s_add_u32 m0, s19, 102400
    s_add_u32 s34, s32, 12288
    buffer_load_dwordx4 v92, s[4:7], s34 offen offset:0 lds
    buffer_load_dwordx4 v93, s[4:7], s34 offen offset:1024 lds
    buffer_load_dwordx4 v94, s[4:7], s34 offen offset:2048 lds
    buffer_load_dwordx4 v95, s[4:7], s34 offen offset:3072 lds
    v_lshlrev_b32 v29, 7, v0
    s_waitcnt vmcnt(12)
    ds_read_b128 a[32:35], v8 offset:32768
    ds_read_b128 a[36:39], v9 offset:32768
    ds_read_b128 a[40:43], v10 offset:32768
    ds_read_b128 a[44:47], v11 offset:32768
    s_mov_b32 s17, 0x8000
    s_add_u32 s36, s19, 0x18000
    s_mov_b32 s18, 1
    s_add_u32 s16, s19, 0x8000
    s_mov_b32 m0, s16
    s_waitcnt vmcnt(8) lgkmcnt(0)
    s_barrier
    ds_read_b128 a[64:67], v4 offset:0
    ds_read_b128 a[68:71], v4 offset:4096
    ds_read_b128 a[72:75], v4 offset:8192
    ds_read_b128 a[76:79], v4 offset:12288
    ds_read_b128 a[92:95], v4 offset:13312
    ds_read_b128 a[88:91], v4 offset:9216
    ds_read_b128 a[84:87], v4 offset:5120
    ds_read_b128 a[80:83], v4 offset:1024
    s_waitcnt lgkmcnt(4)
    v_mfma_f32_16x16x32_bf16 v[64:67], a[64:67], a[0:3], v[32:35]
    ds_read_b128 a[96:99], v4 offset:2048
    ds_read_b128 a[100:103], v4 offset:6144
    v_mfma_f32_16x16x32_bf16 v[64:67], a[68:71], a[4:7], v[64:67]
    ds_read_b128 a[104:107], v4 offset:10240
    ds_read_b128 a[108:111], v4 offset:14336
    v_mfma_f32_16x16x32_bf16 v[64:67], a[72:75], a[8:11], v[64:67]
    ds_read_b128 a[124:127], v4 offset:15360
    ds_read_b128 a[120:123], v4 offset:11264
    v_mfma_f32_16x16x32_bf16 v[64:67], a[76:79], a[12:15], v[64:67]
    ds_read_b128 a[116:119], v4 offset:7168
    ds_read_b128 a[112:115], v4 offset:3072
    s_waitcnt lgkmcnt(8)
    v_mfma_f32_16x16x32_bf16 v[68:71], a[92:95], a[12:15], v[36:39]
    buffer_load_dwordx4 v1, s[8:11], s16 offen offset:0 sc1 lds
    v_mfma_f32_16x16x32_bf16 v[68:71], a[88:91], a[8:11], v[68:71]
    v_mfma_f32_16x16x32_bf16 v[68:71], a[84:87], a[4:7], v[68:71]
    buffer_load_dwordx4 v1, s[8:11], s16 offen offset:1024 sc1 lds
    v_mfma_f32_16x16x32_bf16 v[68:71], a[80:83], a[0:3], v[68:71]
    s_waitcnt vmcnt(6) lgkmcnt(4)
    s_barrier
    v_mfma_f32_16x16x32_bf16 v[72:75], a[96:99], a[0:3], v[40:43]
    v_exp_f32 v64, v64
    v_mfma_f32_16x16x32_bf16 v[72:75], a[100:103], a[4:7], v[72:75]
    ds_read_b128 a[128:131], v3 offset:16384
    ds_read_b128 a[132:135], v3 offset:17408
    v_mfma_f32_16x16x32_bf16 v[72:75], a[104:107], a[8:11], v[72:75]
    v_exp_f32 v65, v65
    v_mfma_f32_16x16x32_bf16 v[72:75], a[108:111], a[12:15], v[72:75]
    s_waitcnt lgkmcnt(2)
    v_cvt_pk_bf16_f32 v64, v64, v65
    v_mfma_f32_16x16x32_bf16 v[76:79], a[124:127], a[12:15], v[44:47]
    v_exp_f32 v66, v66
    v_mfma_f32_16x16x32_bf16 v[76:79], a[120:123], a[8:11], v[76:79]
    ds_read_b128 a[136:139], v3 offset:18432
    ds_read_b128 a[140:143], v3 offset:19456
    v_mfma_f32_16x16x32_bf16 v[76:79], a[116:119], a[4:7], v[76:79]
    v_exp_f32 v67, v67
    v_mfma_f32_16x16x32_bf16 v[76:79], a[112:115], a[0:3], v[76:79]
    buffer_load_dwordx4 v1, s[8:11], s16 offen offset:2048 sc1 lds
    v_cvt_pk_bf16_f32 v65, v66, v67
    v_exp_f32 v68, v68
    v_exp_f32 v69, v69
    ds_read_b128 a[144:147], v3 offset:20480
    ds_read_b128 a[148:151], v3 offset:21504
    v_exp_f32 v70, v70
    v_cvt_pk_bf16_f32 v66, v68, v69
    buffer_load_dwordx4 v1, s[8:11], s16 offen offset:3072 sc1 lds
    v_exp_f32 v71, v71
    s_add_u32 m0, s19, 0x9000
    ds_read_b128 a[152:155], v3 offset:22528
    ds_read_b128 a[156:159], v3 offset:23552
    v_exp_f32 v72, v72
    v_cvt_pk_bf16_f32 v67, v70, v71
    v_exp_f32 v73, v73
    buffer_load_dwordx4 v2, s[8:11], s16 offen offset:0 sc1 lds
    v_exp_f32 v74, v74
    v_cvt_pk_bf16_f32 v68, v72, v73
    v_exp_f32 v75, v75
    ds_read_b128 a[160:163], v3 offset:24576
    ds_read_b128 a[164:167], v3 offset:25600
    v_cvt_pk_bf16_f32 v69, v74, v75
    v_mfma_f32_16x16x32_bf16 v[80:83], a[64:67], a[16:19], v[32:35]
    v_exp_f32 v76, v76
    v_mfma_f32_16x16x32_bf16 v[80:83], a[68:71], a[20:23], v[80:83]
    ds_read_b128 a[168:171], v3 offset:26624
    ds_read_b128 a[172:175], v3 offset:27648
    v_mfma_f32_16x16x32_bf16 v[80:83], a[72:75], a[24:27], v[80:83]
    v_exp_f32 v77, v77
    v_mfma_f32_16x16x32_bf16 v[80:83], a[76:79], a[28:31], v[80:83]
    buffer_load_dwordx4 v2, s[8:11], s16 offen offset:1024 sc1 lds
    v_cvt_pk_bf16_f32 v70, v76, v77
    v_mfma_f32_16x16x32_bf16 v[84:87], a[92:95], a[28:31], v[36:39]
    v_exp_f32 v78, v78
    v_mfma_f32_16x16x32_bf16 v[84:87], a[88:91], a[24:27], v[84:87]
    ds_read_b128 a[176:179], v3 offset:28672
    ds_read_b128 a[180:183], v3 offset:29696
    v_mfma_f32_16x16x32_bf16 v[84:87], a[84:87], a[20:23], v[84:87]
    v_exp_f32 v79, v79
    v_mfma_f32_16x16x32_bf16 v[84:87], a[80:83], a[16:19], v[84:87]
    buffer_load_dwordx4 v2, s[8:11], s16 offen offset:2048 sc1 lds
    v_cvt_pk_bf16_f32 v71, v78, v79
    v_mfma_f32_16x16x32_bf16 v[88:91], a[96:99], a[16:19], v[40:43]
    v_exp_f32 v80, v80
    v_mfma_f32_16x16x32_bf16 v[88:91], a[100:103], a[20:23], v[88:91]
    ds_read_b128 a[184:187], v3 offset:30720
    ds_read_b128 a[188:191], v3 offset:31744
    v_mfma_f32_16x16x32_bf16 v[88:91], a[104:107], a[24:27], v[88:91]
    v_exp_f32 v81, v81
    v_mfma_f32_16x16x32_bf16 v[88:91], a[108:111], a[28:31], v[88:91]
    buffer_load_dwordx4 v2, s[8:11], s16 offen offset:3072 sc1 lds
    v_cvt_pk_bf16_f32 v80, v80, v81
    v_mfma_f32_16x16x32_bf16 v[92:95], a[124:127], a[28:31], v[44:47]
    s_add_u32 s16, s16, 0x8000
    v_exp_f32 v82, v82
    v_mfma_f32_16x16x32_bf16 v[92:95], a[120:123], a[24:27], v[92:95]
    ds_read_b128 a[192:195], v7
    v_mfma_f32_16x16x32_bf16 v[92:95], a[116:119], a[20:23], v[92:95]
    s_add_u32 m0, s19, 0x10000
    v_exp_f32 v83, v83
    v_mfma_f32_16x16x32_bf16 v[92:95], a[112:115], a[16:19], v[92:95]
    s_waitcnt lgkmcnt(7)
    v_cvt_pk_bf16_f32 v81, v82, v83
    v_mfma_f32_16x16x32_bf16 v[128:131], a[128:131], v[64:67], v[128:131]
    v_exp_f32 v84, v84
    v_mfma_f32_16x16x32_bf16 v[128:131], a[132:135], v[68:71], v[128:131]
    v_mfma_f32_16x16x32_bf16 v[132:135], a[136:139], v[64:67], v[132:135]
    v_exp_f32 v85, v85
    v_mfma_f32_16x16x32_bf16 v[132:135], a[140:143], v[68:71], v[132:135]
    v_cvt_pk_bf16_f32 v82, v84, v85
    v_mfma_f32_16x16x32_bf16 v[136:139], a[144:147], v[64:67], v[136:139]
    v_exp_f32 v86, v86
    v_mfma_f32_16x16x32_bf16 v[136:139], a[148:151], v[68:71], v[136:139]
    v_mfma_f32_16x16x32_bf16 v[140:143], a[152:155], v[64:67], v[140:143]
    v_exp_f32 v87, v87
    v_mfma_f32_16x16x32_bf16 v[140:143], a[156:159], v[68:71], v[140:143]
    v_cvt_pk_bf16_f32 v83, v86, v87
    v_mfma_f32_16x16x32_bf16 v[144:147], a[160:163], v[64:67], v[144:147]
    s_waitcnt lgkmcnt(0)
    v_exp_f32 v88, v88
    v_mfma_f32_16x16x32_bf16 v[144:147], a[164:167], v[68:71], v[144:147]
    v_mfma_f32_16x16x32_bf16 v[148:151], a[168:171], v[64:67], v[148:151]
    v_exp_f32 v89, v89
    v_mfma_f32_16x16x32_bf16 v[148:151], a[172:175], v[68:71], v[148:151]
    v_cvt_pk_bf16_f32 v84, v88, v89
    v_mfma_f32_16x16x32_bf16 v[152:155], a[176:179], v[64:67], v[152:155]
    v_exp_f32 v90, v90
    v_mfma_f32_16x16x32_bf16 v[152:155], a[180:183], v[68:71], v[152:155]
    buffer_load_dword v30, v29, s[84:87], 0 offen sc1
    v_mfma_f32_16x16x32_bf16 v[156:159], a[184:187], v[64:67], v[156:159]
    v_exp_f32 v91, v91
    v_mfma_f32_16x16x32_bf16 v[156:159], a[188:191], v[68:71], v[156:159]
    v_cvt_pk_bf16_f32 v85, v90, v91
    v_smfmac_f32_16x16x64_bf16 v[48:51], a[192:195], v[64:71], v26
    v_mfma_f32_16x16x32_bf16 v[64:67], a[64:67], a[32:35], v[32:35]
    v_exp_f32 v92, v92
    v_mfma_f32_16x16x32_bf16 v[64:67], a[68:71], a[36:39], v[64:67]
    buffer_load_dwordx4 v1, s[8:11], s16 offen offset:0 sc1 lds
    v_mfma_f32_16x16x32_bf16 v[64:67], a[72:75], a[40:43], v[64:67]
    v_exp_f32 v93, v93
    v_mfma_f32_16x16x32_bf16 v[64:67], a[76:79], a[44:47], v[64:67]
    v_cvt_pk_bf16_f32 v86, v92, v93
    v_add_u32 v5, 256, v5
    v_mfma_f32_16x16x32_bf16 v[68:71], a[92:95], a[44:47], v[36:39]
    v_exp_f32 v94, v94
    v_mfma_f32_16x16x32_bf16 v[68:71], a[88:91], a[40:43], v[68:71]
    buffer_load_dwordx4 v1, s[8:11], s16 offen offset:1024 sc1 lds
    v_mfma_f32_16x16x32_bf16 v[68:71], a[84:87], a[36:39], v[68:71]
    v_exp_f32 v95, v95
    v_mfma_f32_16x16x32_bf16 v[68:71], a[80:83], a[32:35], v[68:71]
    v_cvt_pk_bf16_f32 v87, v94, v95
    v_add_u32 v7, 512, v7
    v_mfma_f32_16x16x32_bf16 v[72:75], a[96:99], a[32:35], v[40:43]
    v_exp_f32 v64, v64
    v_mfma_f32_16x16x32_bf16 v[72:75], a[100:103], a[36:39], v[72:75]
    buffer_load_dwordx4 v1, s[8:11], s16 offen offset:2048 sc1 lds
    v_mfma_f32_16x16x32_bf16 v[72:75], a[104:107], a[40:43], v[72:75]
    v_exp_f32 v65, v65
    v_mfma_f32_16x16x32_bf16 v[72:75], a[108:111], a[44:47], v[72:75]
    v_cvt_pk_bf16_f32 v64, v64, v65
    v_add_u32 v3, s17, v1
    v_mfma_f32_16x16x32_bf16 v[76:79], a[124:127], a[44:47], v[44:47]
    v_exp_f32 v66, v66
    v_mfma_f32_16x16x32_bf16 v[76:79], a[120:123], a[40:43], v[76:79]
    buffer_load_dwordx4 v1, s[8:11], s16 offen offset:3072 sc1 lds
    v_mfma_f32_16x16x32_bf16 v[76:79], a[116:119], a[36:39], v[76:79]
    s_add_u32 m0, s19, 0x11000
    v_exp_f32 v67, v67
    v_mfma_f32_16x16x32_bf16 v[76:79], a[112:115], a[32:35], v[76:79]
    v_cvt_pk_bf16_f32 v65, v66, v67
    v_add_u32 v4, s17, v31
    v_mfma_f32_16x16x32_bf16 v[160:163], a[128:131], v[80:83], v[160:163]
    v_exp_f32 v68, v68
    v_mfma_f32_16x16x32_bf16 v[160:163], a[132:135], v[84:87], v[160:163]
    buffer_load_dwordx4 v2, s[8:11], s16 offen offset:0 sc1 lds
    v_mfma_f32_16x16x32_bf16 v[164:167], a[136:139], v[80:83], v[164:167]
    v_exp_f32 v69, v69
    v_mfma_f32_16x16x32_bf16 v[164:167], a[140:143], v[84:87], v[164:167]
    v_cvt_pk_bf16_f32 v66, v68, v69
    v_mfma_f32_16x16x32_bf16 v[168:171], a[144:147], v[80:83], v[168:171]
    s_waitcnt vmcnt(14)
    v_exp_f32 v70, v70
    v_mfma_f32_16x16x32_bf16 v[168:171], a[148:151], v[84:87], v[168:171]
    ds_read_b128 a[48:51], v8 offset:36864
    ds_read_b128 a[52:55], v9 offset:36864
    v_mfma_f32_16x16x32_bf16 v[172:175], a[152:155], v[80:83], v[172:175]
    v_exp_f32 v71, v71
    v_mfma_f32_16x16x32_bf16 v[172:175], a[156:159], v[84:87], v[172:175]
    buffer_load_dwordx4 v2, s[8:11], s16 offen offset:1024 sc1 lds
    v_cvt_pk_bf16_f32 v67, v70, v71
    v_mfma_f32_16x16x32_bf16 v[176:179], a[160:163], v[80:83], v[176:179]
    v_exp_f32 v72, v72
    v_mfma_f32_16x16x32_bf16 v[176:179], a[164:167], v[84:87], v[176:179]
    ds_read_b128 a[56:59], v10 offset:36864
    ds_read_b128 a[60:63], v11 offset:36864
    v_mfma_f32_16x16x32_bf16 v[180:183], a[168:171], v[80:83], v[180:183]
    v_exp_f32 v73, v73
    v_mfma_f32_16x16x32_bf16 v[180:183], a[172:175], v[84:87], v[180:183]
    buffer_load_dwordx4 v2, s[8:11], s16 offen offset:2048 sc1 lds
    v_cvt_pk_bf16_f32 v68, v72, v73
    v_mfma_f32_16x16x32_bf16 v[184:187], a[176:179], v[80:83], v[184:187]
    v_exp_f32 v74, v74
    v_mfma_f32_16x16x32_bf16 v[184:187], a[180:183], v[84:87], v[184:187]
    buffer_load_dwordx4 v2, s[8:11], s16 offen offset:3072 sc1 lds
    v_mfma_f32_16x16x32_bf16 v[188:191], a[184:187], v[80:83], v[188:191]
    v_exp_f32 v75, v75
    v_mfma_f32_16x16x32_bf16 v[188:191], a[188:191], v[84:87], v[188:191]
    s_waitcnt vmcnt(8) lgkmcnt(0)
    v_cvt_pk_bf16_f32 v69, v74, v75
    v_cmp_ne_u32 vcc, v30, v28
    v_smfmac_f32_16x16x64_bf16 v[52:55], a[192:195], v[80:87], v26
    s_cbranch_vccnz Lm_poll2
Lm_got2:
    s_barrier
    v_mfma_f32_16x16x32_bf16 v[80:83], a[64:67], a[48:51], v[32:35]
    buffer_load_dwordx4 v[12:15], v27, s[20:23], s25 offen
    v_exp_f32 v76, v76
    v_mfma_f32_16x16x32_bf16 v[80:83], a[68:71], a[52:55], v[80:83]
    ds_read_b128 v[32:35], v5 offset:0
    ds_read_b128 a[64:67], v4 offset:0
    v_mfma_f32_16x16x32_bf16 v[80:83], a[72:75], a[56:59], v[80:83]
    v_exp_f32 v77, v77
    v_mfma_f32_16x16x32_bf16 v[80:83], a[76:79], a[60:63], v[80:83]
    ds_read_b128 a[68:71], v4 offset:4096
    v_cvt_pk_bf16_f32 v70, v76, v77
    v_mfma_f32_16x16x32_bf16 v[84:87], a[92:95], a[60:63], v[36:39]
    buffer_load_dwordx4 v[16:19], v27, s[20:23], s26 offen
    v_exp_f32 v78, v78
    v_mfma_f32_16x16x32_bf16 v[84:87], a[88:91], a[56:59], v[84:87]
    ds_read_b128 a[72:75], v4 offset:8192
    ds_read_b128 a[76:79], v4 offset:12288
    v_mfma_f32_16x16x32_bf16 v[84:87], a[84:87], a[52:55], v[84:87]
    v_exp_f32 v79, v79
    v_mfma_f32_16x16x32_bf16 v[84:87], a[80:83], a[48:51], v[84:87]
    buffer_load_dwordx4 v[20:23], v27, s[20:23], s27 offen
    v_cvt_pk_bf16_f32 v71, v78, v79
    v_mfma_f32_16x16x32_bf16 v[88:91], a[96:99], a[48:51], v[40:43]
    v_exp_f32 v80, v80
    v_mfma_f32_16x16x32_bf16 v[88:91], a[100:103], a[52:55], v[88:91]
    ds_read_b128 v[36:39], v5 offset:64
    ds_read_b128 a[92:95], v4 offset:13312
    v_mfma_f32_16x16x32_bf16 v[88:91], a[104:107], a[56:59], v[88:91]
    v_exp_f32 v81, v81
    v_mfma_f32_16x16x32_bf16 v[88:91], a[108:111], a[60:63], v[88:91]
    ds_read_b128 a[88:91], v4 offset:9216
    v_cvt_pk_bf16_f32 v80, v80, v81
    v_mfma_f32_16x16x32_bf16 v[92:95], a[124:127], a[60:63], v[44:47]
    buffer_load_dwordx4 v[112:115], v27, s[20:23], s28 offen
    v_exp_f32 v82, v82
    v_mfma_f32_16x16x32_bf16 v[92:95], a[120:123], a[56:59], v[92:95]
    ds_read_b128 a[84:87], v4 offset:5120
    ds_read_b128 a[80:83], v4 offset:1024
    v_mfma_f32_16x16x32_bf16 v[92:95], a[116:119], a[52:55], v[92:95]
    v_exp_f32 v83, v83
    v_mfma_f32_16x16x32_bf16 v[92:95], a[112:115], a[48:51], v[92:95]
    buffer_load_dwordx4 v[116:119], v27, s[20:23], s29 offen
    v_cvt_pk_bf16_f32 v81, v82, v83
    v_mfma_f32_16x16x32_bf16 v[192:195], a[128:131], v[64:67], v[192:195]
    v_exp_f32 v84, v84
    v_mfma_f32_16x16x32_bf16 v[192:195], a[132:135], v[68:71], v[192:195]
    ds_read_b128 v[40:43], v5 offset:128
    ds_read_b128 a[96:99], v4 offset:2048
    v_mfma_f32_16x16x32_bf16 v[196:199], a[136:139], v[64:67], v[196:199]
    v_exp_f32 v85, v85
    v_mfma_f32_16x16x32_bf16 v[196:199], a[140:143], v[68:71], v[196:199]
    ds_read_b128 a[100:103], v4 offset:6144
    v_cvt_pk_bf16_f32 v82, v84, v85
    v_mfma_f32_16x16x32_bf16 v[200:203], a[144:147], v[64:67], v[200:203]
    buffer_load_dwordx4 v[120:123], v27, s[20:23], s30 offen
    v_exp_f32 v86, v86
    v_mfma_f32_16x16x32_bf16 v[200:203], a[148:151], v[68:71], v[200:203]
    ds_read_b128 a[104:107], v4 offset:10240
    ds_read_b128 a[108:111], v4 offset:14336
    v_mfma_f32_16x16x32_bf16 v[204:207], a[152:155], v[64:67], v[204:207]
    v_exp_f32 v87, v87
    v_mfma_f32_16x16x32_bf16 v[204:207], a[156:159], v[68:71], v[204:207]
    buffer_load_dwordx4 v[124:127], v27, s[20:23], s31 offen
    v_cvt_pk_bf16_f32 v83, v86, v87
    v_mfma_f32_16x16x32_bf16 v[208:211], a[160:163], v[64:67], v[208:211]
    v_exp_f32 v88, v88
    v_mfma_f32_16x16x32_bf16 v[208:211], a[164:167], v[68:71], v[208:211]
    ds_read_b128 v[44:47], v5 offset:192
    ds_read_b128 a[124:127], v4 offset:15360
    v_mfma_f32_16x16x32_bf16 v[212:215], a[168:171], v[64:67], v[212:215]
    v_exp_f32 v89, v89
    v_mfma_f32_16x16x32_bf16 v[212:215], a[172:175], v[68:71], v[212:215]
    ds_read_b128 a[120:123], v4 offset:11264
    v_cvt_pk_bf16_f32 v84, v88, v89
    v_mfma_f32_16x16x32_bf16 v[216:219], a[176:179], v[64:67], v[216:219]
    buffer_load_dwordx4 v[8:11], v27, s[20:23], s24 offen
    v_exp_f32 v90, v90
    v_mfma_f32_16x16x32_bf16 v[216:219], a[180:183], v[68:71], v[216:219]
    ds_read_b128 a[116:119], v4 offset:7168
    ds_read_b128 a[112:115], v4 offset:3072
    v_mfma_f32_16x16x32_bf16 v[220:223], a[184:187], v[64:67], v[220:223]
    v_exp_f32 v91, v91
    v_mfma_f32_16x16x32_bf16 v[220:223], a[188:191], v[68:71], v[220:223]
    v_cvt_pk_bf16_f32 v85, v90, v91
    v_smfmac_f32_16x16x64_bf16 v[56:59], a[192:195], v[64:71], v26
    s_waitcnt lgkmcnt(10)
    s_add_u32 s16, s16, 0x8000
Lm_loop:
    v_mfma_f32_16x16x32_bf16 v[64:67], a[64:67], a[0:3], v[32:35]
    v_exp_f32 v92, v92
    v_mfma_f32_16x16x32_bf16 v[64:67], a[68:71], a[4:7], v[64:67]
    v_mfma_f32_16x16x32_bf16 v[64:67], a[72:75], a[8:11], v[64:67]
    v_exp_f32 v93, v93
    v_mfma_f32_16x16x32_bf16 v[64:67], a[76:79], a[12:15], v[64:67]
    v_cvt_pk_bf16_f32 v86, v92, v93
    v_mfma_f32_16x16x32_bf16 v[68:71], a[92:95], a[12:15], v[36:39]
    s_mov_b32 m0, s36
    v_exp_f32 v94, v94
    v_mfma_f32_16x16x32_bf16 v[68:71], a[88:91], a[8:11], v[68:71]
    buffer_load_dwordx4 v1, s[8:11], s16 offen offset:0 sc1 lds
    v_mfma_f32_16x16x32_bf16 v[68:71], a[84:87], a[4:7], v[68:71]
    v_exp_f32 v95, v95
    v_mfma_f32_16x16x32_bf16 v[68:71], a[80:83], a[0:3], v[68:71]
    s_waitcnt lgkmcnt(0)
    v_cvt_pk_bf16_f32 v87, v94, v95
    v_mfma_f32_16x16x32_bf16 v[72:75], a[96:99], a[0:3], v[40:43]
    v_exp_f32 v64, v64
    v_mfma_f32_16x16x32_bf16 v[72:75], a[100:103], a[4:7], v[72:75]
    v_mfma_f32_16x16x32_bf16 v[72:75], a[104:107], a[8:11], v[72:75]
    v_exp_f32 v65, v65
    v_mfma_f32_16x16x32_bf16 v[72:75], a[108:111], a[12:15], v[72:75]
    v_cvt_pk_bf16_f32 v64, v64, v65
    v_mfma_f32_16x16x32_bf16 v[76:79], a[124:127], a[12:15], v[44:47]
    v_exp_f32 v66, v66
    v_mfma_f32_16x16x32_bf16 v[76:79], a[120:123], a[8:11], v[76:79]
    buffer_load_dwordx4 v1, s[8:11], s16 offen offset:1024 sc1 lds
    v_mfma_f32_16x16x32_bf16 v[76:79], a[116:119], a[4:7], v[76:79]
    v_exp_f32 v67, v67
    v_mfma_f32_16x16x32_bf16 v[76:79], a[112:115], a[0:3], v[76:79]
    v_cvt_pk_bf16_f32 v65, v66, v67
    v_mfma_f32_16x16x32_bf16 v[224:227], a[128:131], v[80:83], v[224:227]
    v_exp_f32 v68, v68
    v_mfma_f32_16x16x32_bf16 v[224:227], a[132:135], v[84:87], v[224:227]
    ds_read_b128 a[128:131], v3 offset:16384
    ds_read_b128 a[132:135], v3 offset:17408
    v_mfma_f32_16x16x32_bf16 v[228:231], a[136:139], v[80:83], v[228:231]
    v_exp_f32 v69, v69
    v_mfma_f32_16x16x32_bf16 v[228:231], a[140:143], v[84:87], v[228:231]
    v_cvt_pk_bf16_f32 v66, v68, v69
    v_mfma_f32_16x16x32_bf16 v[232:235], a[144:147], v[80:83], v[232:235]
    v_exp_f32 v70, v70
    v_mfma_f32_16x16x32_bf16 v[232:235], a[148:151], v[84:87], v[232:235]
    ds_read_b128 a[136:139], v3 offset:18432
    ds_read_b128 a[140:143], v3 offset:19456
    v_mfma_f32_16x16x32_bf16 v[236:239], a[152:155], v[80:83], v[236:239]
    v_exp_f32 v71, v71
    v_mfma_f32_16x16x32_bf16 v[236:239], a[156:159], v[84:87], v[236:239]
    v_cvt_pk_bf16_f32 v67, v70, v71
    v_mfma_f32_16x16x32_bf16 v[240:243], a[160:163], v[80:83], v[240:243]
    v_exp_f32 v72, v72
    v_mfma_f32_16x16x32_bf16 v[240:243], a[164:167], v[84:87], v[240:243]
    ds_read_b128 a[144:147], v3 offset:20480
    ds_read_b128 a[148:151], v3 offset:21504
    v_mfma_f32_16x16x32_bf16 v[244:247], a[168:171], v[80:83], v[244:247]
    v_exp_f32 v73, v73
    v_mfma_f32_16x16x32_bf16 v[244:247], a[172:175], v[84:87], v[244:247]
    v_cvt_pk_bf16_f32 v68, v72, v73
    v_mfma_f32_16x16x32_bf16 v[248:251], a[176:179], v[80:83], v[248:251]
    v_exp_f32 v74, v74
    v_mfma_f32_16x16x32_bf16 v[248:251], a[180:183], v[84:87], v[248:251]
    ds_read_b128 a[152:155], v3 offset:22528
    ds_read_b128 a[156:159], v3 offset:23552
    v_mfma_f32_16x16x32_bf16 v[252:255], a[184:187], v[80:83], v[252:255]
    v_exp_f32 v75, v75
    v_mfma_f32_16x16x32_bf16 v[252:255], a[188:191], v[84:87], v[252:255]
    v_cvt_pk_bf16_f32 v69, v74, v75
    v_smfmac_f32_16x16x64_bf16 v[60:63], a[192:195], v[80:87], v26
    ds_read_b128 a[160:163], v3 offset:24576
    ds_read_b128 a[164:167], v3 offset:25600
    v_mfma_f32_16x16x32_bf16 v[80:83], a[64:67], a[16:19], v[32:35]
    v_exp_f32 v76, v76
    v_mfma_f32_16x16x32_bf16 v[80:83], a[68:71], a[20:23], v[80:83]
    ds_read_b128 a[168:171], v3 offset:26624
    ds_read_b128 a[172:175], v3 offset:27648
    v_mfma_f32_16x16x32_bf16 v[80:83], a[72:75], a[24:27], v[80:83]
    v_exp_f32 v77, v77
    v_mfma_f32_16x16x32_bf16 v[80:83], a[76:79], a[28:31], v[80:83]
    v_cvt_pk_bf16_f32 v70, v76, v77
    v_mfma_f32_16x16x32_bf16 v[84:87], a[92:95], a[28:31], v[36:39]
    v_exp_f32 v78, v78
    v_mfma_f32_16x16x32_bf16 v[84:87], a[88:91], a[24:27], v[84:87]
    ds_read_b128 a[176:179], v3 offset:28672
    ds_read_b128 a[180:183], v3 offset:29696
    v_mfma_f32_16x16x32_bf16 v[84:87], a[84:87], a[20:23], v[84:87]
    v_exp_f32 v79, v79
    v_mfma_f32_16x16x32_bf16 v[84:87], a[80:83], a[16:19], v[84:87]
    v_cvt_pk_bf16_f32 v71, v78, v79
    v_mfma_f32_16x16x32_bf16 v[88:91], a[96:99], a[16:19], v[40:43]
    v_exp_f32 v80, v80
    v_mfma_f32_16x16x32_bf16 v[88:91], a[100:103], a[20:23], v[88:91]
    ds_read_b128 a[184:187], v3 offset:30720
    ds_read_b128 a[188:191], v3 offset:31744
    v_mfma_f32_16x16x32_bf16 v[88:91], a[104:107], a[24:27], v[88:91]
    v_exp_f32 v81, v81
    v_mfma_f32_16x16x32_bf16 v[88:91], a[108:111], a[28:31], v[88:91]
    v_cvt_pk_bf16_f32 v80, v80, v81
    v_mfma_f32_16x16x32_bf16 v[92:95], a[124:127], a[28:31], v[44:47]
    v_exp_f32 v82, v82
    v_mfma_f32_16x16x32_bf16 v[92:95], a[120:123], a[24:27], v[92:95]
    ds_read_b128 a[192:195], v7
    v_mfma_f32_16x16x32_bf16 v[92:95], a[116:119], a[20:23], v[92:95]
    v_exp_f32 v83, v83
    v_mfma_f32_16x16x32_bf16 v[92:95], a[112:115], a[16:19], v[92:95]
    s_waitcnt lgkmcnt(7)
    v_cvt_pk_bf16_f32 v81, v82, v83
    v_mfma_f32_16x16x32_bf16 v[128:131], a[128:131], v[64:67], v[128:131]
    v_exp_f32 v84, v84
    v_mfma_f32_16x16x32_bf16 v[128:131], a[132:135], v[68:71], v[128:131]
    v_mfma_f32_16x16x32_bf16 v[132:135], a[136:139], v[64:67], v[132:135]
    v_exp_f32 v85, v85
    v_mfma_f32_16x16x32_bf16 v[132:135], a[140:143], v[68:71], v[132:135]
    v_cvt_pk_bf16_f32 v82, v84, v85
    v_mfma_f32_16x16x32_bf16 v[136:139], a[144:147], v[64:67], v[136:139]
    v_exp_f32 v86, v86
    v_mfma_f32_16x16x32_bf16 v[136:139], a[148:151], v[68:71], v[136:139]
    buffer_load_dwordx4 v1, s[8:11], s16 offen offset:2048 sc1 lds
    v_mfma_f32_16x16x32_bf16 v[140:143], a[152:155], v[64:67], v[140:143]
    v_exp_f32 v87, v87
    v_mfma_f32_16x16x32_bf16 v[140:143], a[156:159], v[68:71], v[140:143]
    v_cvt_pk_bf16_f32 v83, v86, v87
    v_mfma_f32_16x16x32_bf16 v[144:147], a[160:163], v[64:67], v[144:147]
    s_waitcnt lgkmcnt(0)
    v_exp_f32 v88, v88
    v_mfma_f32_16x16x32_bf16 v[144:147], a[164:167], v[68:71], v[144:147]
    v_mfma_f32_16x16x32_bf16 v[148:151], a[168:171], v[64:67], v[148:151]
    v_exp_f32 v89, v89
    v_mfma_f32_16x16x32_bf16 v[148:151], a[172:175], v[68:71], v[148:151]
    v_cvt_pk_bf16_f32 v84, v88, v89
    v_mfma_f32_16x16x32_bf16 v[152:155], a[176:179], v[64:67], v[152:155]
    v_exp_f32 v90, v90
    v_mfma_f32_16x16x32_bf16 v[152:155], a[180:183], v[68:71], v[152:155]
    buffer_load_dwordx4 v1, s[8:11], s16 offen offset:3072 sc1 lds
    v_mfma_f32_16x16x32_bf16 v[156:159], a[184:187], v[64:67], v[156:159]
    s_cmp_eq_u32 s18, s1
    v_exp_f32 v91, v91
    v_mfma_f32_16x16x32_bf16 v[156:159], a[188:191], v[68:71], v[156:159]
    v_cvt_pk_bf16_f32 v85, v90, v91
    v_smfmac_f32_16x16x64_bf16 v[48:51], a[192:195], v[64:71], v26
    s_cbranch_scc1 Lm_hook
Lm_back:
    v_mfma_f32_16x16x32_bf16 v[64:67], a[64:67], a[32:35], v[32:35]
    s_add_u32 s17, s17, 0x8000
    v_exp_f32 v92, v92
    v_mfma_f32_16x16x32_bf16 v[64:67], a[68:71], a[36:39], v[64:67]
    v_add_u32 v5, 256, v5
    v_mfma_f32_16x16x32_bf16 v[64:67], a[72:75], a[40:43], v[64:67]
    s_and_b32 s17, s17, 0x1ffff
    v_exp_f32 v93, v93
    v_mfma_f32_16x16x32_bf16 v[64:67], a[76:79], a[44:47], v[64:67]
    v_cvt_pk_bf16_f32 v86, v92, v93
    v_mfma_f32_16x16x32_bf16 v[68:71], a[92:95], a[44:47], v[36:39]
    s_add_u32 m0, s36, 4096
    v_exp_f32 v94, v94
    v_mfma_f32_16x16x32_bf16 v[68:71], a[88:91], a[40:43], v[68:71]
    buffer_load_dwordx4 v2, s[8:11], s16 offen offset:0 sc1 lds
    v_mfma_f32_16x16x32_bf16 v[68:71], a[84:87], a[36:39], v[68:71]
    v_exp_f32 v95, v95
    v_mfma_f32_16x16x32_bf16 v[68:71], a[80:83], a[32:35], v[68:71]
    v_cvt_pk_bf16_f32 v87, v94, v95
    v_mfma_f32_16x16x32_bf16 v[72:75], a[96:99], a[32:35], v[40:43]
    v_exp_f32 v64, v64
    v_mfma_f32_16x16x32_bf16 v[72:75], a[100:103], a[36:39], v[72:75]
    v_add_u32 v7, 512, v7
    v_mfma_f32_16x16x32_bf16 v[72:75], a[104:107], a[40:43], v[72:75]
    v_exp_f32 v65, v65
    v_mfma_f32_16x16x32_bf16 v[72:75], a[108:111], a[44:47], v[72:75]
    v_cvt_pk_bf16_f32 v64, v64, v65
    v_mfma_f32_16x16x32_bf16 v[76:79], a[124:127], a[44:47], v[44:47]
    s_add_u32 s18, s18, 1
    v_exp_f32 v66, v66
    v_mfma_f32_16x16x32_bf16 v[76:79], a[120:123], a[40:43], v[76:79]
    buffer_load_dwordx4 v2, s[8:11], s16 offen offset:1024 sc1 lds
    v_mfma_f32_16x16x32_bf16 v[76:79], a[116:119], a[36:39], v[76:79]
    s_xor_b32 s36, s17, 0x10000
    v_exp_f32 v67, v67
    v_mfma_f32_16x16x32_bf16 v[76:79], a[112:115], a[32:35], v[76:79]
    v_cvt_pk_bf16_f32 v65, v66, v67
    v_mfma_f32_16x16x32_bf16 v[160:163], a[128:131], v[80:83], v[160:163]
    s_add_u32 s36, s36, s19
    v_exp_f32 v68, v68
    v_mfma_f32_16x16x32_bf16 v[160:163], a[132:135], v[84:87], v[160:163]
    v_add_u32 v3, s17, v1
    v_mfma_f32_16x16x32_bf16 v[164:167], a[136:139], v[80:83], v[164:167]
    v_exp_f32 v69, v69
    v_mfma_f32_16x16x32_bf16 v[164:167], a[140:143], v[84:87], v[164:167]
    v_cvt_pk_bf16_f32 v66, v68, v69
    v_mfma_f32_16x16x32_bf16 v[168:171], a[144:147], v[80:83], v[168:171]
    v_exp_f32 v70, v70
    v_mfma_f32_16x16x32_bf16 v[168:171], a[148:151], v[84:87], v[168:171]
    buffer_load_dwordx4 v2, s[8:11], s16 offen offset:2048 sc1 lds
    v_mfma_f32_16x16x32_bf16 v[172:175], a[152:155], v[80:83], v[172:175]
    v_exp_f32 v71, v71
    v_mfma_f32_16x16x32_bf16 v[172:175], a[156:159], v[84:87], v[172:175]
    v_cvt_pk_bf16_f32 v67, v70, v71
    v_mfma_f32_16x16x32_bf16 v[176:179], a[160:163], v[80:83], v[176:179]
    v_exp_f32 v72, v72
    v_mfma_f32_16x16x32_bf16 v[176:179], a[164:167], v[84:87], v[176:179]
    v_add_u32 v4, s17, v31
    v_mfma_f32_16x16x32_bf16 v[180:183], a[168:171], v[80:83], v[180:183]
    v_exp_f32 v73, v73
    v_mfma_f32_16x16x32_bf16 v[180:183], a[172:175], v[84:87], v[180:183]
    v_cvt_pk_bf16_f32 v68, v72, v73
    v_mfma_f32_16x16x32_bf16 v[184:187], a[176:179], v[80:83], v[184:187]
    v_exp_f32 v74, v74
    v_mfma_f32_16x16x32_bf16 v[184:187], a[180:183], v[84:87], v[184:187]
    buffer_load_dwordx4 v2, s[8:11], s16 offen offset:3072 sc1 lds
    v_mfma_f32_16x16x32_bf16 v[188:191], a[184:187], v[80:83], v[188:191]
    s_add_u32 s16, s16, 0x8000
    v_exp_f32 v75, v75
    v_mfma_f32_16x16x32_bf16 v[188:191], a[188:191], v[84:87], v[188:191]
    s_waitcnt vmcnt(8)
    v_cvt_pk_bf16_f32 v69, v74, v75
    v_smfmac_f32_16x16x64_bf16 v[52:55], a[192:195], v[80:87], v26
    s_barrier
    v_mfma_f32_16x16x32_bf16 v[80:83], a[64:67], a[48:51], v[32:35]
    v_exp_f32 v76, v76
    v_mfma_f32_16x16x32_bf16 v[80:83], a[68:71], a[52:55], v[80:83]
    ds_read_b128 v[32:35], v5 offset:0
    ds_read_b128 a[64:67], v4 offset:0
    v_mfma_f32_16x16x32_bf16 v[80:83], a[72:75], a[56:59], v[80:83]
    v_exp_f32 v77, v77
    v_mfma_f32_16x16x32_bf16 v[80:83], a[76:79], a[60:63], v[80:83]
    ds_read_b128 a[68:71], v4 offset:4096
    v_cvt_pk_bf16_f32 v70, v76, v77
    v_mfma_f32_16x16x32_bf16 v[84:87], a[92:95], a[60:63], v[36:39]
    v_exp_f32 v78, v78
    v_mfma_f32_16x16x32_bf16 v[84:87], a[88:91], a[56:59], v[84:87]
    ds_read_b128 a[72:75], v4 offset:8192
    ds_read_b128 a[76:79], v4 offset:12288
    v_mfma_f32_16x16x32_bf16 v[84:87], a[84:87], a[52:55], v[84:87]
    v_exp_f32 v79, v79
    v_mfma_f32_16x16x32_bf16 v[84:87], a[80:83], a[48:51], v[84:87]
    v_cvt_pk_bf16_f32 v71, v78, v79
    v_mfma_f32_16x16x32_bf16 v[88:91], a[96:99], a[48:51], v[40:43]
    v_exp_f32 v80, v80
    v_mfma_f32_16x16x32_bf16 v[88:91], a[100:103], a[52:55], v[88:91]
    ds_read_b128 v[36:39], v5 offset:64
    ds_read_b128 a[92:95], v4 offset:13312
    v_mfma_f32_16x16x32_bf16 v[88:91], a[104:107], a[56:59], v[88:91]
    v_exp_f32 v81, v81
    v_mfma_f32_16x16x32_bf16 v[88:91], a[108:111], a[60:63], v[88:91]
    ds_read_b128 a[88:91], v4 offset:9216
    v_cvt_pk_bf16_f32 v80, v80, v81
    v_mfma_f32_16x16x32_bf16 v[92:95], a[124:127], a[60:63], v[44:47]
    v_exp_f32 v82, v82
    v_mfma_f32_16x16x32_bf16 v[92:95], a[120:123], a[56:59], v[92:95]
    ds_read_b128 a[84:87], v4 offset:5120
    ds_read_b128 a[80:83], v4 offset:1024
    v_mfma_f32_16x16x32_bf16 v[92:95], a[116:119], a[52:55], v[92:95]
    v_exp_f32 v83, v83
    v_mfma_f32_16x16x32_bf16 v[92:95], a[112:115], a[48:51], v[92:95]
    v_cvt_pk_bf16_f32 v81, v82, v83
    v_mfma_f32_16x16x32_bf16 v[192:195], a[128:131], v[64:67], v[192:195]
    v_exp_f32 v84, v84
    v_mfma_f32_16x16x32_bf16 v[192:195], a[132:135], v[68:71], v[192:195]
    ds_read_b128 v[40:43], v5 offset:128
    ds_read_b128 a[96:99], v4 offset:2048
    v_mfma_f32_16x16x32_bf16 v[196:199], a[136:139], v[64:67], v[196:199]
    v_exp_f32 v85, v85
    v_mfma_f32_16x16x32_bf16 v[196:199], a[140:143], v[68:71], v[196:199]
    ds_read_b128 a[100:103], v4 offset:6144
    v_cvt_pk_bf16_f32 v82, v84, v85
    v_mfma_f32_16x16x32_bf16 v[200:203], a[144:147], v[64:67], v[200:203]
    v_exp_f32 v86, v86
    v_mfma_f32_16x16x32_bf16 v[200:203], a[148:151], v[68:71], v[200:203]
    ds_read_b128 a[104:107], v4 offset:10240
    ds_read_b128 a[108:111], v4 offset:14336
    v_mfma_f32_16x16x32_bf16 v[204:207], a[152:155], v[64:67], v[204:207]
    v_exp_f32 v87, v87
    v_mfma_f32_16x16x32_bf16 v[204:207], a[156:159], v[68:71], v[204:207]
    v_cvt_pk_bf16_f32 v83, v86, v87
    v_mfma_f32_16x16x32_bf16 v[208:211], a[160:163], v[64:67], v[208:211]
    v_exp_f32 v88, v88
    v_mfma_f32_16x16x32_bf16 v[208:211], a[164:167], v[68:71], v[208:211]
    ds_read_b128 v[44:47], v5 offset:192
    ds_read_b128 a[124:127], v4 offset:15360
    v_mfma_f32_16x16x32_bf16 v[212:215], a[168:171], v[64:67], v[212:215]
    v_exp_f32 v89, v89
    v_mfma_f32_16x16x32_bf16 v[212:215], a[172:175], v[68:71], v[212:215]
    ds_read_b128 a[120:123], v4 offset:11264
    v_cvt_pk_bf16_f32 v84, v88, v89
    v_mfma_f32_16x16x32_bf16 v[216:219], a[176:179], v[64:67], v[216:219]
    v_exp_f32 v90, v90
    v_mfma_f32_16x16x32_bf16 v[216:219], a[180:183], v[68:71], v[216:219]
    ds_read_b128 a[116:119], v4 offset:7168
    ds_read_b128 a[112:115], v4 offset:3072
    v_mfma_f32_16x16x32_bf16 v[220:223], a[184:187], v[64:67], v[220:223]
    v_exp_f32 v91, v91
    v_mfma_f32_16x16x32_bf16 v[220:223], a[188:191], v[68:71], v[220:223]
    s_waitcnt lgkmcnt(10)
    v_cvt_pk_bf16_f32 v85, v90, v91
    v_smfmac_f32_16x16x64_bf16 v[56:59], a[192:195], v[64:71], v26
    s_branch Lm_loop
Lm_side2:
    s_cmp_eq_u32 s61, 0
    s_cselect_b32 s1, 4, 31
    s_cmp_eq_u32 s39, 0
    s_cbranch_scc1 Lm_hook_cvtd
    s_mov_b32 s1, 3
    s_mov_b32 s92, 1
    s_cmp_eq_u32 s0, 0
    s_cbranch_scc1 Lm_cvtk
    s_branch Lm_cvtv
Lm_hook_cvtd:
    s_mov_b32 s92, 0
    v_accvgpr_read_b32 v8, a196
    v_accvgpr_read_b32 v9, a197
    v_accvgpr_read_b32 v10, a198
    v_accvgpr_read_b32 v11, a199
    v_accvgpr_read_b32 v12, a200
    v_accvgpr_read_b32 v13, a201
    v_accvgpr_read_b32 v14, a202
    v_accvgpr_read_b32 v15, a203
    v_accvgpr_read_b32 v16, a204
    s_mov_b32 s86, 0x4000
    v_mov_b32 v28, s99
    v_add_u32 v29, 8192, v29
    s_branch Lm_back
Lm_side3:
    s_mov_b32 s1, 31
    s_mov_b64 exec, 1
    s_waitcnt vmcnt(8)
    buffer_store_dword v28, off, s[84:87], s95 sc1
    s_mov_b64 exec, -1
    s_branch Lm_back
Lm_side4:
    s_mov_b32 s1, 5
    buffer_load_dwordx3 v[20:22], v29, s[84:87], 0 offen sc1
    s_branch Lm_back
Lm_side5:
    s_mov_b32 s1, 31
    s_waitcnt vmcnt(8)
    v_xor_b32 v20, v20, v28
    v_xor_b32 v21, v21, v28
    v_xor_b32 v22, v22, v28
    v_or3_b32 v20, v20, v21, v22
    v_cmp_ne_u32 vcc, 0, v20
    s_cbranch_vccz Lm_back
    s_branch Lm_poll3
Lm_hook:
    s_cmp_eq_u32 s18, 2
    s_cbranch_scc1 Lm_side2
    s_cmp_eq_u32 s18, 3
    s_cbranch_scc1 Lm_side3
    s_cmp_eq_u32 s18, 5
    s_cbranch_scc1 Lm_side5
    s_cmp_eq_u32 s18, 4
    s_cbranch_scc1 Lm_side4
    v_mfma_f32_16x16x32_bf16 v[64:67], a[64:67], a[32:35], v[32:35]
    v_exp_f32 v92, v92
    v_mfma_f32_16x16x32_bf16 v[64:67], a[68:71], a[36:39], v[64:67]
    v_mfma_f32_16x16x32_bf16 v[64:67], a[72:75], a[40:43], v[64:67]
    v_exp_f32 v93, v93
    v_mfma_f32_16x16x32_bf16 v[64:67], a[76:79], a[44:47], v[64:67]
    v_cvt_pk_bf16_f32 v86, v92, v93
    s_or_b32 s16, s3, s61
    s_cbranch_scc1 Lm_noarrive
    s_mov_b32 s84, s80
    s_and_b32 s85, s81, 0xffff
    s_mov_b32 s86, 0x100
    s_and_b32 s16, s37, 0xc0
    v_mov_b32 v6, 1
    s_mov_b64 exec, 1
    buffer_atomic_add v6, off, s[84:87], s16 sc0 sc1
    s_mov_b64 exec, -1
Lm_noarrive:
    v_add_f32 v48, v48, v49
    v_add_f32 v50, v50, v51
    s_nop 1
    v_permlane32_swap_b32 v48, v50
    v_add_f32 v49, v48, v50
    v_add_f32 v50, v48, v50
    s_nop 1
    v_permlane32_swap_b32 v49, v50
    v_rcp_f32 v48, v49
    s_nop 0
    v_mul_f32 v50, -v50, v48
    v_pk_fma_f32 v[128:129], v[128:129], v[48:49], v[50:51] op_sel:[0,0,0] op_sel_hi:[1,0,0]
    v_pk_fma_f32 v[132:133], v[132:133], v[48:49], v[50:51] op_sel:[0,0,0] op_sel_hi:[1,0,0]
    v_pk_fma_f32 v[136:137], v[136:137], v[48:49], v[50:51] op_sel:[0,0,0] op_sel_hi:[1,0,0]
    v_pk_fma_f32 v[140:141], v[140:141], v[48:49], v[50:51] op_sel:[0,0,0] op_sel_hi:[1,0,0]
    v_pk_fma_f32 v[130:131], v[130:131], v[48:49], v[50:51] op_sel:[0,0,0] op_sel_hi:[1,0,0]
    v_pk_fma_f32 v[134:135], v[134:135], v[48:49], v[50:51] op_sel:[0,0,0] op_sel_hi:[1,0,0]
    v_pk_fma_f32 v[138:139], v[138:139], v[48:49], v[50:51] op_sel:[0,0,0] op_sel_hi:[1,0,0]
    v_pk_fma_f32 v[142:143], v[142:143], v[48:49], v[50:51] op_sel:[0,0,0] op_sel_hi:[1,0,0]
    v_pk_fma_f32 v[144:145], v[144:145], v[48:49], v[50:51] op_sel:[0,0,0] op_sel_hi:[1,0,0]
    v_pk_fma_f32 v[148:149], v[148:149], v[48:49], v[50:51] op_sel:[0,0,0] op_sel_hi:[1,0,0]
    v_pk_fma_f32 v[152:153], v[152:153], v[48:49], v[50:51] op_sel:[0,0,0] op_sel_hi:[1,0,0]
    v_pk_fma_f32 v[156:157], v[156:157], v[48:49], v[50:51] op_sel:[0,0,0] op_sel_hi:[1,0,0]
    v_pk_fma_f32 v[146:147], v[146:147], v[48:49], v[50:51] op_sel:[0,0,0] op_sel_hi:[1,0,0]
    v_pk_fma_f32 v[150:151], v[150:151], v[48:49], v[50:51] op_sel:[0,0,0] op_sel_hi:[1,0,0]
    v_pk_fma_f32 v[154:155], v[154:155], v[48:49], v[50:51] op_sel:[0,0,0] op_sel_hi:[1,0,0]
    v_pk_fma_f32 v[158:159], v[158:159], v[48:49], v[50:51] op_sel:[0,0,0] op_sel_hi:[1,0,0]
    v_cvt_pk_bf16_f32 v96, v128, v132
    v_cvt_pk_bf16_f32 v97, v136, v140
    v_cvt_pk_bf16_f32 v98, v129, v133
    v_cvt_pk_bf16_f32 v99, v137, v141
    v_mfma_f32_16x16x32_bf16 v[68:71], a[92:95], a[44:47], v[36:39]
    v_exp_f32 v94, v94
    v_mfma_f32_16x16x32_bf16 v[68:71], a[88:91], a[40:43], v[68:71]
    v_cvt_pk_bf16_f32 v100, v130, v134
    v_cvt_pk_bf16_f32 v101, v138, v142
    v_mfma_f32_16x16x32_bf16 v[68:71], a[84:87], a[36:39], v[68:71]
    v_exp_f32 v95, v95
    v_mfma_f32_16x16x32_bf16 v[68:71], a[80:83], a[32:35], v[68:71]
    ds_write_b128 v8, v[96:99] offset:0
    v_cvt_pk_bf16_f32 v87, v94, v95
    v_mfma_f32_16x16x32_bf16 v[72:75], a[96:99], a[32:35], v[40:43]
    v_exp_f32 v64, v64
    v_mfma_f32_16x16x32_bf16 v[72:75], a[100:103], a[36:39], v[72:75]
    v_cvt_pk_bf16_f32 v102, v131, v135
    v_cvt_pk_bf16_f32 v103, v139, v143
    v_mfma_f32_16x16x32_bf16 v[72:75], a[104:107], a[40:43], v[72:75]
    v_exp_f32 v65, v65
    v_mfma_f32_16x16x32_bf16 v[72:75], a[108:111], a[44:47], v[72:75]
    ds_write_b128 v9, v[100:103] offset:0
    v_cvt_pk_bf16_f32 v64, v64, v65
    v_mfma_f32_16x16x32_bf16 v[76:79], a[124:127], a[44:47], v[44:47]
    v_exp_f32 v66, v66
    v_mfma_f32_16x16x32_bf16 v[76:79], a[120:123], a[40:43], v[76:79]
    v_cvt_pk_bf16_f32 v104, v144, v148
    v_cvt_pk_bf16_f32 v105, v152, v156
    v_mfma_f32_16x16x32_bf16 v[76:79], a[116:119], a[36:39], v[76:79]
    v_exp_f32 v67, v67
    v_mfma_f32_16x16x32_bf16 v[76:79], a[112:115], a[32:35], v[76:79]
    v_cvt_pk_bf16_f32 v65, v66, v67
    v_cvt_pk_bf16_f32 v106, v145, v149
    v_mfma_f32_16x16x32_bf16 v[160:163], a[128:131], v[80:83], v[160:163]
    v_exp_f32 v68, v68
    v_mfma_f32_16x16x32_bf16 v[160:163], a[132:135], v[84:87], v[160:163]
    v_cvt_pk_bf16_f32 v107, v153, v157
    v_cvt_pk_bf16_f32 v108, v146, v150
    v_mfma_f32_16x16x32_bf16 v[164:167], a[136:139], v[80:83], v[164:167]
    v_exp_f32 v69, v69
    v_mfma_f32_16x16x32_bf16 v[164:167], a[140:143], v[84:87], v[164:167]
    ds_write_b128 v10, v[104:107] offset:0
    v_cvt_pk_bf16_f32 v66, v68, v69
    v_mfma_f32_16x16x32_bf16 v[168:171], a[144:147], v[80:83], v[168:171]
    v_exp_f32 v70, v70
    v_mfma_f32_16x16x32_bf16 v[168:171], a[148:151], v[84:87], v[168:171]
    v_cvt_pk_bf16_f32 v109, v154, v158
    v_cvt_pk_bf16_f32 v110, v147, v151
    v_mfma_f32_16x16x32_bf16 v[172:175], a[152:155], v[80:83], v[172:175]
    v_exp_f32 v71, v71
    v_mfma_f32_16x16x32_bf16 v[172:175], a[156:159], v[84:87], v[172:175]
    v_cvt_pk_bf16_f32 v67, v70, v71
    v_cvt_pk_bf16_f32 v111, v155, v159
    v_mfma_f32_16x16x32_bf16 v[176:179], a[160:163], v[80:83], v[176:179]
    v_exp_f32 v72, v72
    v_mfma_f32_16x16x32_bf16 v[176:179], a[164:167], v[84:87], v[176:179]
    ds_write_b128 v11, v[108:111] offset:0
    ds_read_b128 v[128:131], v16 offset:0
    v_mfma_f32_16x16x32_bf16 v[180:183], a[168:171], v[80:83], v[180:183]
    v_exp_f32 v73, v73
    v_mfma_f32_16x16x32_bf16 v[180:183], a[172:175], v[84:87], v[180:183]
    ds_read_b128 v[132:135], v16 offset:1024
    v_cvt_pk_bf16_f32 v68, v72, v73
    v_mfma_f32_16x16x32_bf16 v[184:187], a[176:179], v[80:83], v[184:187]
    v_exp_f32 v74, v74
    v_mfma_f32_16x16x32_bf16 v[184:187], a[180:183], v[84:87], v[184:187]
    ds_read_b128 v[136:139], v16 offset:2048
    ds_read_b128 v[140:143], v16 offset:3072
    v_mfma_f32_16x16x32_bf16 v[188:191], a[184:187], v[80:83], v[188:191]
    v_exp_f32 v75, v75
    v_mfma_f32_16x16x32_bf16 v[188:191], a[188:191], v[84:87], v[188:191]
    v_cvt_pk_bf16_f32 v69, v74, v75
    v_smfmac_f32_16x16x64_bf16 v[52:55], a[192:195], v[80:87], v26
    s_waitcnt lgkmcnt(0)
    s_add_u32 s16, s32, 0
    buffer_store_dwordx4 v[128:131], v12, s[12:15], s16 offen offset:0 nt
    v_mfma_f32_16x16x32_bf16 v[80:83], a[64:67], a[48:51], v[32:35]
    v_exp_f32 v76, v76
    v_mfma_f32_16x16x32_bf16 v[80:83], a[68:71], a[52:55], v[80:83]
    buffer_store_dwordx4 v[132:135], v13, s[12:15], s16 offen offset:1024 nt
    v_mfma_f32_16x16x32_bf16 v[80:83], a[72:75], a[56:59], v[80:83]
    v_exp_f32 v77, v77
    v_mfma_f32_16x16x32_bf16 v[80:83], a[76:79], a[60:63], v[80:83]
    v_cvt_pk_bf16_f32 v70, v76, v77
    v_add_f32 v52, v52, v53
    v_add_f32 v54, v54, v55
    s_nop 1
    v_permlane32_swap_b32 v52, v54
    v_add_f32 v53, v52, v54
    v_add_f32 v54, v52, v54
    s_nop 1
    v_permlane32_swap_b32 v53, v54
    v_rcp_f32 v52, v53
    s_nop 0
    v_mul_f32 v54, -v54, v52
    v_pk_fma_f32 v[160:161], v[160:161], v[52:53], v[54:55] op_sel:[0,0,0] op_sel_hi:[1,0,0]
    v_pk_fma_f32 v[164:165], v[164:165], v[52:53], v[54:55] op_sel:[0,0,0] op_sel_hi:[1,0,0]
    v_pk_fma_f32 v[168:169], v[168:169], v[52:53], v[54:55] op_sel:[0,0,0] op_sel_hi:[1,0,0]
    v_pk_fma_f32 v[172:173], v[172:173], v[52:53], v[54:55] op_sel:[0,0,0] op_sel_hi:[1,0,0]
    v_pk_fma_f32 v[162:163], v[162:163], v[52:53], v[54:55] op_sel:[0,0,0] op_sel_hi:[1,0,0]
    v_pk_fma_f32 v[166:167], v[166:167], v[52:53], v[54:55] op_sel:[0,0,0] op_sel_hi:[1,0,0]
    v_pk_fma_f32 v[170:171], v[170:171], v[52:53], v[54:55] op_sel:[0,0,0] op_sel_hi:[1,0,0]
    v_pk_fma_f32 v[174:175], v[174:175], v[52:53], v[54:55] op_sel:[0,0,0] op_sel_hi:[1,0,0]
    v_pk_fma_f32 v[176:177], v[176:177], v[52:53], v[54:55] op_sel:[0,0,0] op_sel_hi:[1,0,0]
    v_pk_fma_f32 v[180:181], v[180:181], v[52:53], v[54:55] op_sel:[0,0,0] op_sel_hi:[1,0,0]
    v_pk_fma_f32 v[184:185], v[184:185], v[52:53], v[54:55] op_sel:[0,0,0] op_sel_hi:[1,0,0]
    v_pk_fma_f32 v[188:189], v[188:189], v[52:53], v[54:55] op_sel:[0,0,0] op_sel_hi:[1,0,0]
    v_pk_fma_f32 v[178:179], v[178:179], v[52:53], v[54:55] op_sel:[0,0,0] op_sel_hi:[1,0,0]
    v_pk_fma_f32 v[182:183], v[182:183], v[52:53], v[54:55] op_sel:[0,0,0] op_sel_hi:[1,0,0]
    v_pk_fma_f32 v[186:187], v[186:187], v[52:53], v[54:55] op_sel:[0,0,0] op_sel_hi:[1,0,0]
    v_pk_fma_f32 v[190:191], v[190:191], v[52:53], v[54:55] op_sel:[0,0,0] op_sel_hi:[1,0,0]
    v_cvt_pk_bf16_f32 v96, v160, v164
    v_cvt_pk_bf16_f32 v97, v168, v172
    v_cvt_pk_bf16_f32 v98, v161, v165
    v_cvt_pk_bf16_f32 v99, v169, v173
    v_cvt_pk_bf16_f32 v100, v162, v166
    v_cvt_pk_bf16_f32 v101, v170, v174
    v_mfma_f32_16x16x32_bf16 v[84:87], a[92:95], a[60:63], v[36:39]
    v_exp_f32 v78, v78
    v_mfma_f32_16x16x32_bf16 v[84:87], a[88:91], a[56:59], v[84:87]
    buffer_store_dwordx4 v[136:139], v14, s[12:15], s16 offen offset:2048 nt
    v_cvt_pk_bf16_f32 v102, v163, v167
    v_mfma_f32_16x16x32_bf16 v[84:87], a[84:87], a[52:55], v[84:87]
    v_exp_f32 v79, v79
    v_mfma_f32_16x16x32_bf16 v[84:87], a[80:83], a[48:51], v[84:87]
    ds_write_b128 v8, v[96:99] offset:4096
    v_cvt_pk_bf16_f32 v71, v78, v79
    v_mfma_f32_16x16x32_bf16 v[88:91], a[96:99], a[48:51], v[40:43]
    v_exp_f32 v80, v80
    v_mfma_f32_16x16x32_bf16 v[88:91], a[100:103], a[52:55], v[88:91]
    buffer_store_dwordx4 v[140:143], v15, s[12:15], s16 offen offset:3072 nt
    v_cvt_pk_bf16_f32 v103, v171, v175
    v_mfma_f32_16x16x32_bf16 v[88:91], a[104:107], a[56:59], v[88:91]
    v_exp_f32 v81, v81
    v_mfma_f32_16x16x32_bf16 v[88:91], a[108:111], a[60:63], v[88:91]
    ds_write_b128 v9, v[100:103] offset:4096
    v_cvt_pk_bf16_f32 v80, v80, v81
    v_mfma_f32_16x16x32_bf16 v[92:95], a[124:127], a[60:63], v[44:47]
    v_exp_f32 v82, v82
    v_mfma_f32_16x16x32_bf16 v[92:95], a[120:123], a[56:59], v[92:95]
    v_cvt_pk_bf16_f32 v104, v176, v180
    v_cvt_pk_bf16_f32 v105, v184, v188
    v_mfma_f32_16x16x32_bf16 v[92:95], a[116:119], a[52:55], v[92:95]
    v_exp_f32 v83, v83
    v_mfma_f32_16x16x32_bf16 v[92:95], a[112:115], a[48:51], v[92:95]
    v_cvt_pk_bf16_f32 v81, v82, v83
    v_cvt_pk_bf16_f32 v106, v177, v181
    v_mfma_f32_16x16x32_bf16 v[192:195], a[128:131], v[64:67], v[192:195]
    v_exp_f32 v84, v84
    v_mfma_f32_16x16x32_bf16 v[192:195], a[132:135], v[68:71], v[192:195]
    v_cvt_pk_bf16_f32 v107, v185, v189
    v_cvt_pk_bf16_f32 v108, v178, v182
    v_mfma_f32_16x16x32_bf16 v[196:199], a[136:139], v[64:67], v[196:199]
    v_exp_f32 v85, v85
    v_mfma_f32_16x16x32_bf16 v[196:199], a[140:143], v[68:71], v[196:199]
    ds_write_b128 v10, v[104:107] offset:4096
    v_cvt_pk_bf16_f32 v82, v84, v85
    v_mfma_f32_16x16x32_bf16 v[200:203], a[144:147], v[64:67], v[200:203]
    v_exp_f32 v86, v86
    v_mfma_f32_16x16x32_bf16 v[200:203], a[148:151], v[68:71], v[200:203]
    v_cvt_pk_bf16_f32 v109, v186, v190
    v_cvt_pk_bf16_f32 v110, v179, v183
    v_mfma_f32_16x16x32_bf16 v[204:207], a[152:155], v[64:67], v[204:207]
    v_exp_f32 v87, v87
    v_mfma_f32_16x16x32_bf16 v[204:207], a[156:159], v[68:71], v[204:207]
    v_cvt_pk_bf16_f32 v83, v86, v87
    v_cvt_pk_bf16_f32 v111, v187, v191
    v_mfma_f32_16x16x32_bf16 v[208:211], a[160:163], v[64:67], v[208:211]
    v_exp_f32 v88, v88
    v_mfma_f32_16x16x32_bf16 v[208:211], a[164:167], v[68:71], v[208:211]
    ds_write_b128 v11, v[108:111] offset:4096
    ds_read_b128 v[160:163], v16 offset:4096
    v_mfma_f32_16x16x32_bf16 v[212:215], a[168:171], v[64:67], v[212:215]
    v_exp_f32 v89, v89
    v_mfma_f32_16x16x32_bf16 v[212:215], a[172:175], v[68:71], v[212:215]
    ds_read_b128 v[164:167], v16 offset:5120
    v_cvt_pk_bf16_f32 v84, v88, v89
    v_mfma_f32_16x16x32_bf16 v[216:219], a[176:179], v[64:67], v[216:219]
    v_exp_f32 v90, v90
    v_mfma_f32_16x16x32_bf16 v[216:219], a[180:183], v[68:71], v[216:219]
    ds_read_b128 v[168:171], v16 offset:6144
    ds_read_b128 v[172:175], v16 offset:7168
    v_mfma_f32_16x16x32_bf16 v[220:223], a[184:187], v[64:67], v[220:223]
    v_exp_f32 v91, v91
    v_mfma_f32_16x16x32_bf16 v[220:223], a[188:191], v[68:71], v[220:223]
    v_cvt_pk_bf16_f32 v85, v90, v91
    v_smfmac_f32_16x16x64_bf16 v[56:59], a[192:195], v[64:71], v26
    s_waitcnt lgkmcnt(0)
    s_add_u32 s16, s32, 4096
    buffer_store_dwordx4 v[160:163], v12, s[12:15], s16 offen offset:0 nt
    v_exp_f32 v92, v92
    v_exp_f32 v93, v93
    v_exp_f32 v94, v94
    v_exp_f32 v95, v95
    v_cvt_pk_bf16_f32 v86, v92, v93
    v_cvt_pk_bf16_f32 v87, v94, v95
    v_add_f32 v56, v56, v57
    v_add_f32 v58, v58, v59
    s_nop 1
    v_permlane32_swap_b32 v56, v58
    v_add_f32 v57, v56, v58
    v_add_f32 v58, v56, v58
    s_nop 1
    v_permlane32_swap_b32 v57, v58
    v_rcp_f32 v56, v57
    s_nop 0
    v_mul_f32 v58, -v58, v56
    buffer_store_dwordx4 v[164:167], v13, s[12:15], s16 offen offset:1024 nt
    v_pk_fma_f32 v[192:193], v[192:193], v[56:57], v[58:59] op_sel:[0,0,0] op_sel_hi:[1,0,0]
    v_pk_fma_f32 v[196:197], v[196:197], v[56:57], v[58:59] op_sel:[0,0,0] op_sel_hi:[1,0,0]
    v_pk_fma_f32 v[200:201], v[200:201], v[56:57], v[58:59] op_sel:[0,0,0] op_sel_hi:[1,0,0]
    v_pk_fma_f32 v[204:205], v[204:205], v[56:57], v[58:59] op_sel:[0,0,0] op_sel_hi:[1,0,0]
    v_pk_fma_f32 v[194:195], v[194:195], v[56:57], v[58:59] op_sel:[0,0,0] op_sel_hi:[1,0,0]
    v_pk_fma_f32 v[198:199], v[198:199], v[56:57], v[58:59] op_sel:[0,0,0] op_sel_hi:[1,0,0]
    v_pk_fma_f32 v[202:203], v[202:203], v[56:57], v[58:59] op_sel:[0,0,0] op_sel_hi:[1,0,0]
    v_pk_fma_f32 v[206:207], v[206:207], v[56:57], v[58:59] op_sel:[0,0,0] op_sel_hi:[1,0,0]
    v_pk_fma_f32 v[208:209], v[208:209], v[56:57], v[58:59] op_sel:[0,0,0] op_sel_hi:[1,0,0]
    v_pk_fma_f32 v[212:213], v[212:213], v[56:57], v[58:59] op_sel:[0,0,0] op_sel_hi:[1,0,0]
    buffer_store_dwordx4 v[168:171], v14, s[12:15], s16 offen offset:2048 nt
    v_pk_fma_f32 v[216:217], v[216:217], v[56:57], v[58:59] op_sel:[0,0,0] op_sel_hi:[1,0,0]
    v_pk_fma_f32 v[220:221], v[220:221], v[56:57], v[58:59] op_sel:[0,0,0] op_sel_hi:[1,0,0]
    v_pk_fma_f32 v[210:211], v[210:211], v[56:57], v[58:59] op_sel:[0,0,0] op_sel_hi:[1,0,0]
    v_pk_fma_f32 v[214:215], v[214:215], v[56:57], v[58:59] op_sel:[0,0,0] op_sel_hi:[1,0,0]
    v_pk_fma_f32 v[218:219], v[218:219], v[56:57], v[58:59] op_sel:[0,0,0] op_sel_hi:[1,0,0]
    v_pk_fma_f32 v[222:223], v[222:223], v[56:57], v[58:59] op_sel:[0,0,0] op_sel_hi:[1,0,0]
    v_cvt_pk_bf16_f32 v96, v192, v196
    v_cvt_pk_bf16_f32 v97, v200, v204
    v_cvt_pk_bf16_f32 v98, v193, v197
    v_cvt_pk_bf16_f32 v99, v201, v205
    buffer_store_dwordx4 v[172:175], v15, s[12:15], s16 offen offset:3072 nt
    v_smfmac_f32_16x16x64_bf16 v[60:63], a[192:195], v[80:87], v26
    ds_write_b128 v8, v[96:99] offset:0
    v_mfma_f32_16x16x32_bf16 v[224:227], a[128:131], v[80:83], v[224:227]
    v_cvt_pk_bf16_f32 v100, v194, v198
    v_cvt_pk_bf16_f32 v101, v202, v206
    v_mfma_f32_16x16x32_bf16 v[224:227], a[132:135], v[84:87], v[224:227]
    v_cvt_pk_bf16_f32 v102, v195, v199
    v_cvt_pk_bf16_f32 v103, v203, v207
    v_mfma_f32_16x16x32_bf16 v[228:231], a[136:139], v[80:83], v[228:231]
    v_cvt_pk_bf16_f32 v104, v208, v212
    v_cvt_pk_bf16_f32 v105, v216, v220
    v_mfma_f32_16x16x32_bf16 v[228:231], a[140:143], v[84:87], v[228:231]
    ds_write_b128 v9, v[100:103] offset:0
    v_cvt_pk_bf16_f32 v106, v209, v213
    v_mfma_f32_16x16x32_bf16 v[232:235], a[144:147], v[80:83], v[232:235]
    v_cvt_pk_bf16_f32 v107, v217, v221
    v_cvt_pk_bf16_f32 v108, v210, v214
    v_mfma_f32_16x16x32_bf16 v[232:235], a[148:151], v[84:87], v[232:235]
    ds_write_b128 v10, v[104:107] offset:0
    v_cvt_pk_bf16_f32 v109, v218, v222
    v_mfma_f32_16x16x32_bf16 v[236:239], a[152:155], v[80:83], v[236:239]
    v_cvt_pk_bf16_f32 v110, v211, v215
    v_cvt_pk_bf16_f32 v111, v219, v223
    v_mfma_f32_16x16x32_bf16 v[236:239], a[156:159], v[84:87], v[236:239]
    ds_write_b128 v11, v[108:111] offset:0
    ds_read_b128 v[192:195], v16 offset:0
    v_mfma_f32_16x16x32_bf16 v[240:243], a[160:163], v[80:83], v[240:243]
    ds_read_b128 v[196:199], v16 offset:1024
    ds_read_b128 v[200:203], v16 offset:2048
    v_mfma_f32_16x16x32_bf16 v[240:243], a[164:167], v[84:87], v[240:243]
    ds_read_b128 v[204:207], v16 offset:3072
    v_add_f32 v60, v60, v61
    v_mfma_f32_16x16x32_bf16 v[244:247], a[168:171], v[80:83], v[244:247]
    v_add_f32 v62, v62, v63
    v_mfma_f32_16x16x32_bf16 v[244:247], a[172:175], v[84:87], v[244:247]
    s_nop 0
    v_permlane32_swap_b32 v60, v62
    v_mfma_f32_16x16x32_bf16 v[248:251], a[176:179], v[80:83], v[248:251]
    s_waitcnt lgkmcnt(0)
    s_add_u32 s16, s32, 8192
    v_add_f32 v61, v60, v62
    v_add_f32 v62, v60, v62
    v_mfma_f32_16x16x32_bf16 v[248:251], a[180:183], v[84:87], v[248:251]
    buffer_store_dwordx4 v[192:195], v12, s[12:15], s16 offen offset:0 nt
    v_mfma_f32_16x16x32_bf16 v[252:255], a[184:187], v[80:83], v[252:255]
    v_permlane32_swap_b32 v61, v62
    v_mfma_f32_16x16x32_bf16 v[252:255], a[188:191], v[84:87], v[252:255]
    buffer_store_dwordx4 v[196:199], v13, s[12:15], s16 offen offset:1024 nt
    v_rcp_f32 v60, v61
    s_nop 0
    v_mul_f32 v62, -v62, v60
    v_pk_fma_f32 v[224:225], v[224:225], v[60:61], v[62:63] op_sel:[0,0,0] op_sel_hi:[1,0,0]
    v_pk_fma_f32 v[228:229], v[228:229], v[60:61], v[62:63] op_sel:[0,0,0] op_sel_hi:[1,0,0]
    v_pk_fma_f32 v[232:233], v[232:233], v[60:61], v[62:63] op_sel:[0,0,0] op_sel_hi:[1,0,0]
    v_pk_fma_f32 v[236:237], v[236:237], v[60:61], v[62:63] op_sel:[0,0,0] op_sel_hi:[1,0,0]
    v_cvt_pk_bf16_f32 v96, v224, v228
    v_cvt_pk_bf16_f32 v97, v232, v236
    v_cvt_pk_bf16_f32 v98, v225, v229
    v_cvt_pk_bf16_f32 v99, v233, v237
    ds_write_b128 v8, v[96:99] offset:4096
    buffer_store_dwordx4 v[200:203], v14, s[12:15], s16 offen offset:2048 nt
    v_pk_fma_f32 v[226:227], v[226:227], v[60:61], v[62:63] op_sel:[0,0,0] op_sel_hi:[1,0,0]
    v_pk_fma_f32 v[230:231], v[230:231], v[60:61], v[62:63] op_sel:[0,0,0] op_sel_hi:[1,0,0]
    v_pk_fma_f32 v[234:235], v[234:235], v[60:61], v[62:63] op_sel:[0,0,0] op_sel_hi:[1,0,0]
    v_pk_fma_f32 v[238:239], v[238:239], v[60:61], v[62:63] op_sel:[0,0,0] op_sel_hi:[1,0,0]
    v_cvt_pk_bf16_f32 v100, v226, v230
    v_cvt_pk_bf16_f32 v101, v234, v238
    v_cvt_pk_bf16_f32 v102, v227, v231
    v_cvt_pk_bf16_f32 v103, v235, v239
    ds_write_b128 v9, v[100:103] offset:4096
    buffer_store_dwordx4 v[204:207], v15, s[12:15], s16 offen offset:3072 nt
    v_pk_fma_f32 v[240:241], v[240:241], v[60:61], v[62:63] op_sel:[0,0,0] op_sel_hi:[1,0,0]
    v_pk_fma_f32 v[244:245], v[244:245], v[60:61], v[62:63] op_sel:[0,0,0] op_sel_hi:[1,0,0]
    v_pk_fma_f32 v[248:249], v[248:249], v[60:61], v[62:63] op_sel:[0,0,0] op_sel_hi:[1,0,0]
    v_pk_fma_f32 v[252:253], v[252:253], v[60:61], v[62:63] op_sel:[0,0,0] op_sel_hi:[1,0,0]
    v_cvt_pk_bf16_f32 v104, v240, v244
    v_cvt_pk_bf16_f32 v105, v248, v252
    v_cvt_pk_bf16_f32 v106, v241, v245
    v_cvt_pk_bf16_f32 v107, v249, v253
    ds_write_b128 v10, v[104:107] offset:4096
    v_pk_fma_f32 v[242:243], v[242:243], v[60:61], v[62:63] op_sel:[0,0,0] op_sel_hi:[1,0,0]
    v_pk_fma_f32 v[246:247], v[246:247], v[60:61], v[62:63] op_sel:[0,0,0] op_sel_hi:[1,0,0]
    v_pk_fma_f32 v[250:251], v[250:251], v[60:61], v[62:63] op_sel:[0,0,0] op_sel_hi:[1,0,0]
    v_pk_fma_f32 v[254:255], v[254:255], v[60:61], v[62:63] op_sel:[0,0,0] op_sel_hi:[1,0,0]
    v_cvt_pk_bf16_f32 v108, v242, v246
    v_cvt_pk_bf16_f32 v109, v250, v254
    v_cvt_pk_bf16_f32 v110, v243, v247
    v_cvt_pk_bf16_f32 v111, v251, v255
    ds_write_b128 v11, v[108:111] offset:4096
    ds_read_b128 v[224:227], v16 offset:4096
    ds_read_b128 v[228:231], v16 offset:5120
    ds_read_b128 v[232:235], v16 offset:6144
    ds_read_b128 v[236:239], v16 offset:7168
    s_add_u32 s16, s32, 12288
    s_waitcnt lgkmcnt(3)
    buffer_store_dwordx4 v[224:227], v12, s[12:15], s16 offen offset:0 nt
    s_waitcnt lgkmcnt(2)
    buffer_store_dwordx4 v[228:231], v13, s[12:15], s16 offen offset:1024 nt
    s_waitcnt lgkmcnt(1)
    buffer_store_dwordx4 v[232:235], v14, s[12:15], s16 offen offset:2048 nt
    s_waitcnt lgkmcnt(0)
    buffer_store_dwordx4 v[236:239], v15, s[12:15], s16 offen offset:3072 nt
Lm_vote:
    v_max3_f32 v17, v48, v52, v56
    v_min3_f32 v18, v48, v52, v56
    v_add_f32 v19, v48, v52
    v_add_f32 v20, v56, v60
    v_max_f32 v17, v17, v60
    v_min_f32 v18, v18, v60
    v_cmp_u_f32 s[38:39], v19, v20
    v_cmp_le_f32 vcc, 0x5a000000, v17
    s_or_b64 s[38:39], s[38:39], vcc
    v_cmp_ge_f32 vcc, 0x2a000000, v18
    s_or_b64 s[38:39], s[38:39], vcc
    s_cselect_b32 s17, 1, 0
    s_or_b32 s17, s17, s100
    v_mov_b32 v18, s17
    s_lshl_b32 s18, s3, 2
    s_add_u32 s18, s18, 155648
    v_mov_b32 v19, s18
    ds_write_b32 v19, v18
    v_mov_b32 v18, 155648
    s_waitcnt lgkmcnt(0)
    s_barrier
    ds_read_b128 v[20:23], v18
    s_waitcnt lgkmcnt(0)
    v_or_b32 v20, v20, v21
    v_or3_b32 v20, v20, v22, v23
    s_nop 0
    v_readfirstlane_b32 s17, v20
    s_cmp_gt_u32 s17, s35
    s_cbranch_scc1 Lm_redo
Lm_epoch:
    s_cmp_lg_u32 s3, 0
    s_cbranch_scc1 Lm_noepoch
    s_or_b32 s18, s61, s35
    s_cbranch_scc1 Lm_noepoch
    s_waitcnt vmcnt(16)
    v_readfirstlane_b32 s18, v6
    s_cmp_lg_u32 s18, 63
    s_cbranch_scc1 Lm_noepoch
    s_add_u32 s84, s82, 4325376
    s_addc_u32 s85, s83, 0
    s_and_b32 s85, s85, 0xffff
    s_mov_b32 s86, 0x200
    s_mov_b32 s87, 0x20000
    s_and_b32 s16, s37, 0xc0
    s_lshl_b32 s16, s16, 1
    v_mov_b32 v18, s99
    s_mov_b64 exec, 1
    buffer_store_dword v18, off, s[84:87], s16
    s_mov_b64 exec, -1
Lm_noepoch:
Lm_done:
    s_endpgm
Lm_codeend:
Lm_poll2:
    buffer_load_dword v30, v29, s[84:87], 0 offen sc1
    s_add_u32 s94, s94, 1
    s_waitcnt vmcnt(0)
    v_cmp_ne_u32 vcc, v30, v28
    s_cbranch_vccz Lm_got2
    s_cmp_lt_u32 s94, 4096
    s_cbranch_scc1 Lm_poll2
    s_mov_b32 s100, 2
    s_branch Lm_got2
Lm_poll3:
    buffer_load_dwordx3 v[20:22], v29, s[84:87], 0 offen sc1
    s_add_u32 s94, s94, 1
    s_waitcnt vmcnt(0)
    v_xor_b32 v20, v20, v28
    v_xor_b32 v21, v21, v28
    v_xor_b32 v22, v22, v28
    v_or3_b32 v20, v20, v21, v22
    v_cmp_ne_u32 vcc, 0, v20
    s_cbranch_vccz Lm_back
    s_cmp_lt_u32 s94, 4096
    s_cbranch_scc1 Lm_poll3
    s_mov_b32 s100, 2
    s_branch Lm_back
Lm_redo:
    s_waitcnt vmcnt(0) lgkmcnt(0)
    s_or_b32 s18, s3, s61
    s_cbranch_scc1 Lm_redo2
    v_readfirstlane_b32 s18, v6
    s_cmp_lg_u32 s18, 63
    s_cbranch_scc1 Lm_redo2
    s_add_u32 s84, s82, 4325376
    s_addc_u32 s85, s83, 0
    s_and_b32 s85, s85, 0xffff
    s_mov_b32 s86, 0x200
    s_mov_b32 s87, 0x20000
    s_and_b32 s16, s37, 0xc0
    s_lshl_b32 s16, s16, 1
    v_mov_b32 v18, s99
    s_mov_b64 exec, 1
    buffer_store_dword v18, off, s[84:87], s16
    s_mov_b64 exec, -1
Lm_redo2:
    s_barrier
    s_cmp_lt_u32 s17, 2
    s_cbranch_scc1 Lm_truemax
    s_mov_b32 s61, 1
    s_mov_b32 s39, 0
    s_mov_b32 s100, 0
    s_and_b32 s62, s37, 0xc0
    s_add_u32 s63, s62, 64
    s_branch Lm_prep
Lm_truemax:
    s_mov_b32 s35, 1
    v_mov_b32 v120, 0
    v_mov_b32 v121, 0
    v_mov_b32 v122, 0
    v_mov_b32 v123, 0
    v_mov_b32 v112, 0xff800000
    v_mov_b32 v113, 0xff800000
    v_mov_b32 v114, 0xff800000
    v_mov_b32 v115, 0xff800000
    v_mfma_f32_32x32x16_bf16 v[128:143], v[120:123], v[120:123], 0
    v_mfma_f32_32x32x16_bf16 v[144:159], v[120:123], v[120:123], 0
    v_mfma_f32_32x32x16_bf16 v[160:175], v[120:123], v[120:123], 0
    v_mfma_f32_32x32x16_bf16 v[176:191], v[120:123], v[120:123], 0
    v_mfma_f32_32x32x16_bf16 v[192:207], v[120:123], v[120:123], 0
    v_mfma_f32_32x32x16_bf16 v[208:223], v[120:123], v[120:123], 0
    v_mfma_f32_32x32x16_bf16 v[224:239], v[120:123], v[120:123], 0
    v_mfma_f32_32x32x16_bf16 v[240:255], v[120:123], v[120:123], 0
    v_mfma_f32_32x32x16_bf16 v[48:63], v[120:123], v[120:123], 0
    v_mov_b32 v3, v1
    v_mov_b32 v4, v31
    s_mov_b32 s16, s19
    s_mov_b32 s18, 0
Lm_fa:
    s_mov_b32 m0, s19
    s_barrier
    buffer_load_dwordx4 v1, s[8:11], s16 offen offset:0 sc1 lds
    buffer_load_dwordx4 v1, s[8:11], s16 offen offset:1024 sc1 lds
    buffer_load_dwordx4 v1, s[8:11], s16 offen offset:2048 sc1 lds
    buffer_load_dwordx4 v1, s[8:11], s16 offen offset:3072 sc1 lds
    s_add_u32 m0, s19, 4096
    s_nop 0
    buffer_load_dwordx4 v2, s[8:11], s16 offen offset:0 sc1 lds
    buffer_load_dwordx4 v2, s[8:11], s16 offen offset:1024 sc1 lds
    buffer_load_dwordx4 v2, s[8:11], s16 offen offset:2048 sc1 lds
    buffer_load_dwordx4 v2, s[8:11], s16 offen offset:3072 sc1 lds
    s_add_u32 s16, s16, 0x8000
    s_waitcnt vmcnt(0)
    s_barrier
    ds_read_b128 a[64:67], v4 offset:0
    ds_read_b128 a[68:71], v4 offset:4096
    ds_read_b128 a[72:75], v4 offset:8192
    ds_read_b128 a[76:79], v4 offset:12288
    ds_read_b128 a[92:95], v4 offset:13312
    ds_read_b128 a[88:91], v4 offset:9216
    ds_read_b128 a[84:87], v4 offset:5120
    ds_read_b128 a[80:83], v4 offset:1024
    s_waitcnt lgkmcnt(0)
    ds_read_b128 a[96:99], v4 offset:2048
    ds_read_b128 a[100:103], v4 offset:6144
    ds_read_b128 a[104:107], v4 offset:10240
    ds_read_b128 a[108:111], v4 offset:14336
    ds_read_b128 a[124:127], v4 offset:15360
    ds_read_b128 a[120:123], v4 offset:11264
    ds_read_b128 a[116:119], v4 offset:7168
    ds_read_b128 a[112:115], v4 offset:3072
    s_waitcnt lgkmcnt(0)
    v_mov_b32 v64, 0
    v_mov_b32 v65, 0
    v_mov_b32 v66, 0
    v_mov_b32 v67, 0
    v_mov_b32 v68, 0
    v_mov_b32 v69, 0
    v_mov_b32 v70, 0
    v_mov_b32 v71, 0
    v_mov_b32 v72, 0
    v_mov_b32 v73, 0
    v_mov_b32 v74, 0
    v_mov_b32 v75, 0
    v_mov_b32 v76, 0
    v_mov_b32 v77, 0
    v_mov_b32 v78, 0
    v_mov_b32 v79, 0
    s_nop 1
    v_mfma_f32_16x16x32_bf16 v[64:67], a[64:67], a[0:3], v[64:67]
    v_mfma_f32_16x16x32_bf16 v[64:67], a[68:71], a[4:7], v[64:67]
    v_mfma_f32_16x16x32_bf16 v[64:67], a[72:75], a[8:11], v[64:67]
    v_mfma_f32_16x16x32_bf16 v[64:67], a[76:79], a[12:15], v[64:67]
    v_mfma_f32_16x16x32_bf16 v[68:71], a[92:95], a[12:15], v[68:71]
    v_mfma_f32_16x16x32_bf16 v[68:71], a[88:91], a[8:11], v[68:71]
    v_mfma_f32_16x16x32_bf16 v[68:71], a[84:87], a[4:7], v[68:71]
    v_mfma_f32_16x16x32_bf16 v[68:71], a[80:83], a[0:3], v[68:71]
    v_mfma_f32_16x16x32_bf16 v[72:75], a[96:99], a[0:3], v[72:75]
    v_mfma_f32_16x16x32_bf16 v[72:75], a[100:103], a[4:7], v[72:75]
    v_mfma_f32_16x16x32_bf16 v[72:75], a[104:107], a[8:11], v[72:75]
    v_mfma_f32_16x16x32_bf16 v[72:75], a[108:111], a[12:15], v[72:75]
    v_mfma_f32_16x16x32_bf16 v[76:79], a[124:127], a[12:15], v[76:79]
    v_mfma_f32_16x16x32_bf16 v[76:79], a[120:123], a[8:11], v[76:79]
    v_mfma_f32_16x16x32_bf16 v[76:79], a[116:119], a[4:7], v[76:79]
    v_mfma_f32_16x16x32_bf16 v[76:79], a[112:115], a[0:3], v[76:79]
    s_nop 7
    v_max3_f32 v112, v64, v65, v112
    v_max3_f32 v112, v66, v67, v112
    v_max3_f32 v112, v68, v69, v112
    v_max3_f32 v112, v70, v71, v112
    v_max3_f32 v112, v72, v73, v112
    v_max3_f32 v112, v74, v75, v112
    v_max3_f32 v112, v76, v77, v112
    v_max3_f32 v112, v78, v79, v112
    v_mov_b32 v80, 0
    v_mov_b32 v81, 0
    v_mov_b32 v82, 0
    v_mov_b32 v83, 0
    v_mov_b32 v84, 0
    v_mov_b32 v85, 0
    v_mov_b32 v86, 0
    v_mov_b32 v87, 0
    v_mov_b32 v88, 0
    v_mov_b32 v89, 0
    v_mov_b32 v90, 0
    v_mov_b32 v91, 0
    v_mov_b32 v92, 0
    v_mov_b32 v93, 0
    v_mov_b32 v94, 0
    v_mov_b32 v95, 0
    s_nop 1
    v_mfma_f32_16x16x32_bf16 v[80:83], a[64:67], a[16:19], v[80:83]
    v_mfma_f32_16x16x32_bf16 v[80:83], a[68:71], a[20:23], v[80:83]
    v_mfma_f32_16x16x32_bf16 v[80:83], a[72:75], a[24:27], v[80:83]
    v_mfma_f32_16x16x32_bf16 v[80:83], a[76:79], a[28:31], v[80:83]
    v_mfma_f32_16x16x32_bf16 v[84:87], a[92:95], a[28:31], v[84:87]
    v_mfma_f32_16x16x32_bf16 v[84:87], a[88:91], a[24:27], v[84:87]
    v_mfma_f32_16x16x32_bf16 v[84:87], a[84:87], a[20:23], v[84:87]
    v_mfma_f32_16x16x32_bf16 v[84:87], a[80:83], a[16:19], v[84:87]
    v_mfma_f32_16x16x32_bf16 v[88:91], a[96:99], a[16:19], v[88:91]
    v_mfma_f32_16x16x32_bf16 v[88:91], a[100:103], a[20:23], v[88:91]
    v_mfma_f32_16x16x32_bf16 v[88:91], a[104:107], a[24:27], v[88:91]
    v_mfma_f32_16x16x32_bf16 v[88:91], a[108:111], a[28:31], v[88:91]
    v_mfma_f32_16x16x32_bf16 v[92:95], a[124:127], a[28:31], v[92:95]
    v_mfma_f32_16x16x32_bf16 v[92:95], a[120:123], a[24:27], v[92:95]
    v_mfma_f32_16x16x32_bf16 v[92:95], a[116:119], a[20:23], v[92:95]
    v_mfma_f32_16x16x32_bf16 v[92:95], a[112:115], a[16:19], v[92:95]
    s_nop 7
    v_max3_f32 v113, v80, v81, v113
    v_max3_f32 v113, v82, v83, v113
    v_max3_f32 v113, v84, v85, v113
    v_max3_f32 v113, v86, v87, v113
    v_max3_f32 v113, v88, v89, v113
    v_max3_f32 v113, v90, v91, v113
    v_max3_f32 v113, v92, v93, v113
    v_max3_f32 v113, v94, v95, v113
    v_mov_b32 v64, 0
    v_mov_b32 v65, 0
    v_mov_b32 v66, 0
    v_mov_b32 v67, 0
    v_mov_b32 v68, 0
    v_mov_b32 v69, 0
    v_mov_b32 v70, 0
    v_mov_b32 v71, 0
    v_mov_b32 v72, 0
    v_mov_b32 v73, 0
    v_mov_b32 v74, 0
    v_mov_b32 v75, 0
    v_mov_b32 v76, 0
    v_mov_b32 v77, 0
    v_mov_b32 v78, 0
    v_mov_b32 v79, 0
    s_nop 1
    v_mfma_f32_16x16x32_bf16 v[64:67], a[64:67], a[32:35], v[64:67]
    v_mfma_f32_16x16x32_bf16 v[64:67], a[68:71], a[36:39], v[64:67]
    v_mfma_f32_16x16x32_bf16 v[64:67], a[72:75], a[40:43], v[64:67]
    v_mfma_f32_16x16x32_bf16 v[64:67], a[76:79], a[44:47], v[64:67]
    v_mfma_f32_16x16x32_bf16 v[68:71], a[92:95], a[44:47], v[68:71]
    v_mfma_f32_16x16x32_bf16 v[68:71], a[88:91], a[40:43], v[68:71]
    v_mfma_f32_16x16x32_bf16 v[68:71], a[84:87], a[36:39], v[68:71]
    v_mfma_f32_16x16x32_bf16 v[68:71], a[80:83], a[32:35], v[68:71]
    v_mfma_f32_16x16x32_bf16 v[72:75], a[96:99], a[32:35], v[72:75]
    v_mfma_f32_16x16x32_bf16 v[72:75], a[100:103], a[36:39], v[72:75]
    v_mfma_f32_16x16x32_bf16 v[72:75], a[104:107], a[40:43], v[72:75]
    v_mfma_f32_16x16x32_bf16 v[72:75], a[108:111], a[44:47], v[72:75]
    v_mfma_f32_16x16x32_bf16 v[76:79], a[124:127], a[44:47], v[76:79]
    v_mfma_f32_16x16x32_bf16 v[76:79], a[120:123], a[40:43], v[76:79]
    v_mfma_f32_16x16x32_bf16 v[76:79], a[116:119], a[36:39], v[76:79]
    v_mfma_f32_16x16x32_bf16 v[76:79], a[112:115], a[32:35], v[76:79]
    s_nop 7
    v_max3_f32 v114, v64, v65, v114
    v_max3_f32 v114, v66, v67, v114
    v_max3_f32 v114, v68, v69, v114
    v_max3_f32 v114, v70, v71, v114
    v_max3_f32 v114, v72, v73, v114
    v_max3_f32 v114, v74, v75, v114
    v_max3_f32 v114, v76, v77, v114
    v_max3_f32 v114, v78, v79, v114
    v_mov_b32 v80, 0
    v_mov_b32 v81, 0
    v_mov_b32 v82, 0
    v_mov_b32 v83, 0
    v_mov_b32 v84, 0
    v_mov_b32 v85, 0
    v_mov_b32 v86, 0
    v_mov_b32 v87, 0
    v_mov_b32 v88, 0
    v_mov_b32 v89, 0
    v_mov_b32 v90, 0
    v_mov_b32 v91, 0
    v_mov_b32 v92, 0
    v_mov_b32 v93, 0
    v_mov_b32 v94, 0
    v_mov_b32 v95, 0
    s_nop 1
    v_mfma_f32_16x16x32_bf16 v[80:83], a[64:67], a[48:51], v[80:83]
    v_mfma_f32_16x16x32_bf16 v[80:83], a[68:71], a[52:55], v[80:83]
    v_mfma_f32_16x16x32_bf16 v[80:83], a[72:75], a[56:59], v[80:83]
    v_mfma_f32_16x16x32_bf16 v[80:83], a[76:79], a[60:63], v[80:83]
    v_mfma_f32_16x16x32_bf16 v[84:87], a[92:95], a[60:63], v[84:87]
    v_mfma_f32_16x16x32_bf16 v[84:87], a[88:91], a[56:59], v[84:87]
    v_mfma_f32_16x16x32_bf16 v[84:87], a[84:87], a[52:55], v[84:87]
    v_mfma_f32_16x16x32_bf16 v[84:87], a[80:83], a[48:51], v[84:87]
    v_mfma_f32_16x16x32_bf16 v[88:91], a[96:99], a[48:51], v[88:91]
    v_mfma_f32_16x16x32_bf16 v[88:91], a[100:103], a[52:55], v[88:91]
    v_mfma_f32_16x16x32_bf16 v[88:91], a[104:107], a[56:59], v[88:91]
    v_mfma_f32_16x16x32_bf16 v[88:91], a[108:111], a[60:63], v[88:91]
    v_mfma_f32_16x16x32_bf16 v[92:95], a[124:127], a[60:63], v[92:95]
    v_mfma_f32_16x16x32_bf16 v[92:95], a[120:123], a[56:59], v[92:95]
    v_mfma_f32_16x16x32_bf16 v[92:95], a[116:119], a[52:55], v[92:95]
    v_mfma_f32_16x16x32_bf16 v[92:95], a[112:115], a[48:51], v[92:95]
    s_nop 7
    v_max3_f32 v115, v80, v81, v115
    v_max3_f32 v115, v82, v83, v115
    v_max3_f32 v115, v84, v85, v115
    v_max3_f32 v115, v86, v87, v115
    v_max3_f32 v115, v88, v89, v115
    v_max3_f32 v115, v90, v91, v115
    v_max3_f32 v115, v92, v93, v115
    v_max3_f32 v115, v94, v95, v115
    s_add_u32 s18, s18, 1
    s_cmp_lt_u32 s18, 32
    s_cbranch_scc1 Lm_fa
    v_mov_b32 v116, v112
    v_mov_b32 v117, v113
    v_mov_b32 v118, v114
    v_mov_b32 v119, v115
    v_permlane32_swap_b32 v116, v112
    v_permlane32_swap_b32 v117, v113
    v_permlane32_swap_b32 v118, v114
    v_permlane32_swap_b32 v119, v115
    v_max_f32 v112, v116, v112
    v_max_f32 v113, v117, v113
    v_max_f32 v114, v118, v114
    v_max_f32 v115, v119, v115
    v_mov_b32 v116, v112
    v_mov_b32 v117, v113
    v_mov_b32 v118, v114
    v_mov_b32 v119, v115
    v_permlane16_swap_b32 v116, v112
    v_permlane16_swap_b32 v117, v113
    v_permlane16_swap_b32 v118, v114
    v_permlane16_swap_b32 v119, v115
    v_max_f32 v112, v116, v112
    v_max_f32 v113, v117, v113
    v_max_f32 v114, v118, v114
    v_max_f32 v115, v119, v115
    v_subrev_u32 v5, 7936, v5
    v_subrev_u32 v7, 15872, v7
    s_mov_b32 s16, s19
    s_mov_b32 s18, 0
Lm_fb:
    s_mov_b32 m0, s19
    s_barrier
    buffer_load_dwordx4 v1, s[8:11], s16 offen offset:0 sc1 lds
    buffer_load_dwordx4 v1, s[8:11], s16 offen offset:1024 sc1 lds
    buffer_load_dwordx4 v1, s[8:11], s16 offen offset:2048 sc1 lds
    buffer_load_dwordx4 v1, s[8:11], s16 offen offset:3072 sc1 lds
    s_add_u32 m0, s19, 4096
    s_nop 0
    buffer_load_dwordx4 v2, s[8:11], s16 offen offset:0 sc1 lds
    buffer_load_dwordx4 v2, s[8:11], s16 offen offset:1024 sc1 lds
    buffer_load_dwordx4 v2, s[8:11], s16 offen offset:2048 sc1 lds
    buffer_load_dwordx4 v2, s[8:11], s16 offen offset:3072 sc1 lds
    s_add_u32 s16, s16, 0x8000
    s_waitcnt vmcnt(0)
    s_barrier
    ds_read_b128 a[64:67], v4 offset:0
    ds_read_b128 a[68:71], v4 offset:4096
    ds_read_b128 a[72:75], v4 offset:8192
    ds_read_b128 a[76:79], v4 offset:12288
    ds_read_b128 a[92:95], v4 offset:13312
    ds_read_b128 a[88:91], v4 offset:9216
    ds_read_b128 a[84:87], v4 offset:5120
    ds_read_b128 a[80:83], v4 offset:1024
    s_waitcnt lgkmcnt(0)
    ds_read_b128 a[96:99], v4 offset:2048
    ds_read_b128 a[100:103], v4 offset:6144
    ds_read_b128 a[104:107], v4 offset:10240
    ds_read_b128 a[108:111], v4 offset:14336
    ds_read_b128 a[124:127], v4 offset:15360
    ds_read_b128 a[120:123], v4 offset:11264
    ds_read_b128 a[116:119], v4 offset:7168
    ds_read_b128 a[112:115], v4 offset:3072
    s_waitcnt lgkmcnt(0)
    ds_read_b128 v[32:35], v5 offset:0
    ds_read_b128 v[36:39], v5 offset:64
    ds_read_b128 v[40:43], v5 offset:128
    ds_read_b128 v[44:47], v5 offset:192
    ds_read_b128 a[128:131], v3 offset:16384
    ds_read_b128 a[132:135], v3 offset:17408
    ds_read_b128 a[136:139], v3 offset:18432
    ds_read_b128 a[140:143], v3 offset:19456
    ds_read_b128 a[144:147], v3 offset:20480
    ds_read_b128 a[148:151], v3 offset:21504
    ds_read_b128 a[152:155], v3 offset:22528
    ds_read_b128 a[156:159], v3 offset:23552
    s_waitcnt lgkmcnt(0)
    ds_read_b128 a[160:163], v3 offset:24576
    ds_read_b128 a[164:167], v3 offset:25600
    ds_read_b128 a[168:171], v3 offset:26624
    ds_read_b128 a[172:175], v3 offset:27648
    ds_read_b128 a[176:179], v3 offset:28672
    ds_read_b128 a[180:183], v3 offset:29696
    ds_read_b128 a[184:187], v3 offset:30720
    ds_read_b128 a[188:191], v3 offset:31744
    ds_read_b128 a[192:195], v7
    s_waitcnt lgkmcnt(0)
    v_sub_f32 v64, v32, v112
    v_sub_f32 v65, v33, v112
    v_sub_f32 v66, v34, v112
    v_sub_f32 v67, v35, v112
    v_sub_f32 v68, v36, v112
    v_sub_f32 v69, v37, v112
    v_sub_f32 v70, v38, v112
    v_sub_f32 v71, v39, v112
    v_sub_f32 v72, v40, v112
    v_sub_f32 v73, v41, v112
    v_sub_f32 v74, v42, v112
    v_sub_f32 v75, v43, v112
    v_sub_f32 v76, v44, v112
    v_sub_f32 v77, v45, v112
    v_sub_f32 v78, v46, v112
    v_sub_f32 v79, v47, v112
    s_nop 1
    v_mfma_f32_16x16x32_bf16 v[64:67], a[64:67], a[0:3], v[64:67]
    v_mfma_f32_16x16x32_bf16 v[64:67], a[68:71], a[4:7], v[64:67]
    v_mfma_f32_16x16x32_bf16 v[64:67], a[72:75], a[8:11], v[64:67]
    v_mfma_f32_16x16x32_bf16 v[64:67], a[76:79], a[12:15], v[64:67]
    v_mfma_f32_16x16x32_bf16 v[68:71], a[92:95], a[12:15], v[68:71]
    v_mfma_f32_16x16x32_bf16 v[68:71], a[88:91], a[8:11], v[68:71]
    v_mfma_f32_16x16x32_bf16 v[68:71], a[84:87], a[4:7], v[68:71]
    v_mfma_f32_16x16x32_bf16 v[68:71], a[80:83], a[0:3], v[68:71]
    v_mfma_f32_16x16x32_bf16 v[72:75], a[96:99], a[0:3], v[72:75]
    v_mfma_f32_16x16x32_bf16 v[72:75], a[100:103], a[4:7], v[72:75]
    v_mfma_f32_16x16x32_bf16 v[72:75], a[104:107], a[8:11], v[72:75]
    v_mfma_f32_16x16x32_bf16 v[72:75], a[108:111], a[12:15], v[72:75]
    v_mfma_f32_16x16x32_bf16 v[76:79], a[124:127], a[12:15], v[76:79]
    v_mfma_f32_16x16x32_bf16 v[76:79], a[120:123], a[8:11], v[76:79]
    v_mfma_f32_16x16x32_bf16 v[76:79], a[116:119], a[4:7], v[76:79]
    v_mfma_f32_16x16x32_bf16 v[76:79], a[112:115], a[0:3], v[76:79]
    s_nop 7
    v_exp_f32 v64, v64
    v_exp_f32 v65, v65
    v_exp_f32 v66, v66
    v_exp_f32 v67, v67
    v_exp_f32 v68, v68
    v_exp_f32 v69, v69
    v_exp_f32 v70, v70
    v_exp_f32 v71, v71
    v_exp_f32 v72, v72
    v_exp_f32 v73, v73
    v_exp_f32 v74, v74
    v_exp_f32 v75, v75
    v_exp_f32 v76, v76
    v_exp_f32 v77, v77
    v_exp_f32 v78, v78
    v_exp_f32 v79, v79
    v_cvt_pk_bf16_f32 v64, v64, v65
    v_cvt_pk_bf16_f32 v65, v66, v67
    v_cvt_pk_bf16_f32 v66, v68, v69
    v_cvt_pk_bf16_f32 v67, v70, v71
    v_cvt_pk_bf16_f32 v68, v72, v73
    v_cvt_pk_bf16_f32 v69, v74, v75
    v_cvt_pk_bf16_f32 v70, v76, v77
    v_cvt_pk_bf16_f32 v71, v78, v79
    s_nop 1
    v_mfma_f32_16x16x32_bf16 v[128:131], a[128:131], v[64:67], v[128:131]
    v_mfma_f32_16x16x32_bf16 v[128:131], a[132:135], v[68:71], v[128:131]
    v_mfma_f32_16x16x32_bf16 v[132:135], a[136:139], v[64:67], v[132:135]
    v_mfma_f32_16x16x32_bf16 v[132:135], a[140:143], v[68:71], v[132:135]
    v_mfma_f32_16x16x32_bf16 v[136:139], a[144:147], v[64:67], v[136:139]
    v_mfma_f32_16x16x32_bf16 v[136:139], a[148:151], v[68:71], v[136:139]
    v_mfma_f32_16x16x32_bf16 v[140:143], a[152:155], v[64:67], v[140:143]
    v_mfma_f32_16x16x32_bf16 v[140:143], a[156:159], v[68:71], v[140:143]
    v_mfma_f32_16x16x32_bf16 v[144:147], a[160:163], v[64:67], v[144:147]
    v_mfma_f32_16x16x32_bf16 v[144:147], a[164:167], v[68:71], v[144:147]
    v_mfma_f32_16x16x32_bf16 v[148:151], a[168:171], v[64:67], v[148:151]
    v_mfma_f32_16x16x32_bf16 v[148:151], a[172:175], v[68:71], v[148:151]
    v_mfma_f32_16x16x32_bf16 v[152:155], a[176:179], v[64:67], v[152:155]
    v_mfma_f32_16x16x32_bf16 v[152:155], a[180:183], v[68:71], v[152:155]
    v_mfma_f32_16x16x32_bf16 v[156:159], a[184:187], v[64:67], v[156:159]
    v_mfma_f32_16x16x32_bf16 v[156:159], a[188:191], v[68:71], v[156:159]
    v_smfmac_f32_16x16x64_bf16 v[48:51], a[192:195], v[64:71], v26
    v_sub_f32 v80, v32, v113
    v_sub_f32 v81, v33, v113
    v_sub_f32 v82, v34, v113
    v_sub_f32 v83, v35, v113
    v_sub_f32 v84, v36, v113
    v_sub_f32 v85, v37, v113
    v_sub_f32 v86, v38, v113
    v_sub_f32 v87, v39, v113
    v_sub_f32 v88, v40, v113
    v_sub_f32 v89, v41, v113
    v_sub_f32 v90, v42, v113
    v_sub_f32 v91, v43, v113
    v_sub_f32 v92, v44, v113
    v_sub_f32 v93, v45, v113
    v_sub_f32 v94, v46, v113
    v_sub_f32 v95, v47, v113
    s_nop 1
    v_mfma_f32_16x16x32_bf16 v[80:83], a[64:67], a[16:19], v[80:83]
    v_mfma_f32_16x16x32_bf16 v[80:83], a[68:71], a[20:23], v[80:83]
    v_mfma_f32_16x16x32_bf16 v[80:83], a[72:75], a[24:27], v[80:83]
    v_mfma_f32_16x16x32_bf16 v[80:83], a[76:79], a[28:31], v[80:83]
    v_mfma_f32_16x16x32_bf16 v[84:87], a[92:95], a[28:31], v[84:87]
    v_mfma_f32_16x16x32_bf16 v[84:87], a[88:91], a[24:27], v[84:87]
    v_mfma_f32_16x16x32_bf16 v[84:87], a[84:87], a[20:23], v[84:87]
    v_mfma_f32_16x16x32_bf16 v[84:87], a[80:83], a[16:19], v[84:87]
    v_mfma_f32_16x16x32_bf16 v[88:91], a[96:99], a[16:19], v[88:91]
    v_mfma_f32_16x16x32_bf16 v[88:91], a[100:103], a[20:23], v[88:91]
    v_mfma_f32_16x16x32_bf16 v[88:91], a[104:107], a[24:27], v[88:91]
    v_mfma_f32_16x16x32_bf16 v[88:91], a[108:111], a[28:31], v[88:91]
    v_mfma_f32_16x16x32_bf16 v[92:95], a[124:127], a[28:31], v[92:95]
    v_mfma_f32_16x16x32_bf16 v[92:95], a[120:123], a[24:27], v[92:95]
    v_mfma_f32_16x16x32_bf16 v[92:95], a[116:119], a[20:23], v[92:95]
    v_mfma_f32_16x16x32_bf16 v[92:95], a[112:115], a[16:19], v[92:95]
    s_nop 7
    v_exp_f32 v80, v80
    v_exp_f32 v81, v81
    v_exp_f32 v82, v82
    v_exp_f32 v83, v83
    v_exp_f32 v84, v84
    v_exp_f32 v85, v85
    v_exp_f32 v86, v86
    v_exp_f32 v87, v87
    v_exp_f32 v88, v88
    v_exp_f32 v89, v89
    v_exp_f32 v90, v90
    v_exp_f32 v91, v91
    v_exp_f32 v92, v92
    v_exp_f32 v93, v93
    v_exp_f32 v94, v94
    v_exp_f32 v95, v95
    v_cvt_pk_bf16_f32 v80, v80, v81
    v_cvt_pk_bf16_f32 v81, v82, v83
    v_cvt_pk_bf16_f32 v82, v84, v85
    v_cvt_pk_bf16_f32 v83, v86, v87
    v_cvt_pk_bf16_f32 v84, v88, v89
    v_cvt_pk_bf16_f32 v85, v90, v91
    v_cvt_pk_bf16_f32 v86, v92, v93
    v_cvt_pk_bf16_f32 v87, v94, v95
    s_nop 1
    v_mfma_f32_16x16x32_bf16 v[160:163], a[128:131], v[80:83], v[160:163]
    v_mfma_f32_16x16x32_bf16 v[160:163], a[132:135], v[84:87], v[160:163]
    v_mfma_f32_16x16x32_bf16 v[164:167], a[136:139], v[80:83], v[164:167]
    v_mfma_f32_16x16x32_bf16 v[164:167], a[140:143], v[84:87], v[164:167]
    v_mfma_f32_16x16x32_bf16 v[168:171], a[144:147], v[80:83], v[168:171]
    v_mfma_f32_16x16x32_bf16 v[168:171], a[148:151], v[84:87], v[168:171]
    v_mfma_f32_16x16x32_bf16 v[172:175], a[152:155], v[80:83], v[172:175]
    v_mfma_f32_16x16x32_bf16 v[172:175], a[156:159], v[84:87], v[172:175]
    v_mfma_f32_16x16x32_bf16 v[176:179], a[160:163], v[80:83], v[176:179]
    v_mfma_f32_16x16x32_bf16 v[176:179], a[164:167], v[84:87], v[176:179]
    v_mfma_f32_16x16x32_bf16 v[180:183], a[168:171], v[80:83], v[180:183]
    v_mfma_f32_16x16x32_bf16 v[180:183], a[172:175], v[84:87], v[180:183]
    v_mfma_f32_16x16x32_bf16 v[184:187], a[176:179], v[80:83], v[184:187]
    v_mfma_f32_16x16x32_bf16 v[184:187], a[180:183], v[84:87], v[184:187]
    v_mfma_f32_16x16x32_bf16 v[188:191], a[184:187], v[80:83], v[188:191]
    v_mfma_f32_16x16x32_bf16 v[188:191], a[188:191], v[84:87], v[188:191]
    v_smfmac_f32_16x16x64_bf16 v[52:55], a[192:195], v[80:87], v26
    v_sub_f32 v64, v32, v114
    v_sub_f32 v65, v33, v114
    v_sub_f32 v66, v34, v114
    v_sub_f32 v67, v35, v114
    v_sub_f32 v68, v36, v114
    v_sub_f32 v69, v37, v114
    v_sub_f32 v70, v38, v114
    v_sub_f32 v71, v39, v114
    v_sub_f32 v72, v40, v114
    v_sub_f32 v73, v41, v114
    v_sub_f32 v74, v42, v114
    v_sub_f32 v75, v43, v114
    v_sub_f32 v76, v44, v114
    v_sub_f32 v77, v45, v114
    v_sub_f32 v78, v46, v114
    v_sub_f32 v79, v47, v114
    s_nop 1
    v_mfma_f32_16x16x32_bf16 v[64:67], a[64:67], a[32:35], v[64:67]
    v_mfma_f32_16x16x32_bf16 v[64:67], a[68:71], a[36:39], v[64:67]
    v_mfma_f32_16x16x32_bf16 v[64:67], a[72:75], a[40:43], v[64:67]
    v_mfma_f32_16x16x32_bf16 v[64:67], a[76:79], a[44:47], v[64:67]
    v_mfma_f32_16x16x32_bf16 v[68:71], a[92:95], a[44:47], v[68:71]
    v_mfma_f32_16x16x32_bf16 v[68:71], a[88:91], a[40:43], v[68:71]
    v_mfma_f32_16x16x32_bf16 v[68:71], a[84:87], a[36:39], v[68:71]
    v_mfma_f32_16x16x32_bf16 v[68:71], a[80:83], a[32:35], v[68:71]
    v_mfma_f32_16x16x32_bf16 v[72:75], a[96:99], a[32:35], v[72:75]
    v_mfma_f32_16x16x32_bf16 v[72:75], a[100:103], a[36:39], v[72:75]
    v_mfma_f32_16x16x32_bf16 v[72:75], a[104:107], a[40:43], v[72:75]
    v_mfma_f32_16x16x32_bf16 v[72:75], a[108:111], a[44:47], v[72:75]
    v_mfma_f32_16x16x32_bf16 v[76:79], a[124:127], a[44:47], v[76:79]
    v_mfma_f32_16x16x32_bf16 v[76:79], a[120:123], a[40:43], v[76:79]
    v_mfma_f32_16x16x32_bf16 v[76:79], a[116:119], a[36:39], v[76:79]
    v_mfma_f32_16x16x32_bf16 v[76:79], a[112:115], a[32:35], v[76:79]
    s_nop 7
    v_exp_f32 v64, v64
    v_exp_f32 v65, v65
    v_exp_f32 v66, v66
    v_exp_f32 v67, v67
    v_exp_f32 v68, v68
    v_exp_f32 v69, v69
    v_exp_f32 v70, v70
    v_exp_f32 v71, v71
    v_exp_f32 v72, v72
    v_exp_f32 v73, v73
    v_exp_f32 v74, v74
    v_exp_f32 v75, v75
    v_exp_f32 v76, v76
    v_exp_f32 v77, v77
    v_exp_f32 v78, v78
    v_exp_f32 v79, v79
    v_cvt_pk_bf16_f32 v64, v64, v65
    v_cvt_pk_bf16_f32 v65, v66, v67
    v_cvt_pk_bf16_f32 v66, v68, v69
    v_cvt_pk_bf16_f32 v67, v70, v71
    v_cvt_pk_bf16_f32 v68, v72, v73
    v_cvt_pk_bf16_f32 v69, v74, v75
    v_cvt_pk_bf16_f32 v70, v76, v77
    v_cvt_pk_bf16_f32 v71, v78, v79
    s_nop 1
    v_mfma_f32_16x16x32_bf16 v[192:195], a[128:131], v[64:67], v[192:195]
    v_mfma_f32_16x16x32_bf16 v[192:195], a[132:135], v[68:71], v[192:195]
    v_mfma_f32_16x16x32_bf16 v[196:199], a[136:139], v[64:67], v[196:199]
    v_mfma_f32_16x16x32_bf16 v[196:199], a[140:143], v[68:71], v[196:199]
    v_mfma_f32_16x16x32_bf16 v[200:203], a[144:147], v[64:67], v[200:203]
    v_mfma_f32_16x16x32_bf16 v[200:203], a[148:151], v[68:71], v[200:203]
    v_mfma_f32_16x16x32_bf16 v[204:207], a[152:155], v[64:67], v[204:207]
    v_mfma_f32_16x16x32_bf16 v[204:207], a[156:159], v[68:71], v[204:207]
    v_mfma_f32_16x16x32_bf16 v[208:211], a[160:163], v[64:67], v[208:211]
    v_mfma_f32_16x16x32_bf16 v[208:211], a[164:167], v[68:71], v[208:211]
    v_mfma_f32_16x16x32_bf16 v[212:215], a[168:171], v[64:67], v[212:215]
    v_mfma_f32_16x16x32_bf16 v[212:215], a[172:175], v[68:71], v[212:215]
    v_mfma_f32_16x16x32_bf16 v[216:219], a[176:179], v[64:67], v[216:219]
    v_mfma_f32_16x16x32_bf16 v[216:219], a[180:183], v[68:71], v[216:219]
    v_mfma_f32_16x16x32_bf16 v[220:223], a[184:187], v[64:67], v[220:223]
    v_mfma_f32_16x16x32_bf16 v[220:223], a[188:191], v[68:71], v[220:223]
    v_smfmac_f32_16x16x64_bf16 v[56:59], a[192:195], v[64:71], v26
    v_sub_f32 v80, v32, v115
    v_sub_f32 v81, v33, v115
    v_sub_f32 v82, v34, v115
    v_sub_f32 v83, v35, v115
    v_sub_f32 v84, v36, v115
    v_sub_f32 v85, v37, v115
    v_sub_f32 v86, v38, v115
    v_sub_f32 v87, v39, v115
    v_sub_f32 v88, v40, v115
    v_sub_f32 v89, v41, v115
    v_sub_f32 v90, v42, v115
    v_sub_f32 v91, v43, v115
    v_sub_f32 v92, v44, v115
    v_sub_f32 v93, v45, v115
    v_sub_f32 v94, v46, v115
    v_sub_f32 v95, v47, v115
    s_nop 1
    v_mfma_f32_16x16x32_bf16 v[80:83], a[64:67], a[48:51], v[80:83]
    v_mfma_f32_16x16x32_bf16 v[80:83], a[68:71], a[52:55], v[80:83]
    v_mfma_f32_16x16x32_bf16 v[80:83], a[72:75], a[56:59], v[80:83]
    v_mfma_f32_16x16x32_bf16 v[80:83], a[76:79], a[60:63], v[80:83]
    v_mfma_f32_16x16x32_bf16 v[84:87], a[92:95], a[60:63], v[84:87]
    v_mfma_f32_16x16x32_bf16 v[84:87], a[88:91], a[56:59], v[84:87]
    v_mfma_f32_16x16x32_bf16 v[84:87], a[84:87], a[52:55], v[84:87]
    v_mfma_f32_16x16x32_bf16 v[84:87], a[80:83], a[48:51], v[84:87]
    v_mfma_f32_16x16x32_bf16 v[88:91], a[96:99], a[48:51], v[88:91]
    v_mfma_f32_16x16x32_bf16 v[88:91], a[100:103], a[52:55], v[88:91]
    v_mfma_f32_16x16x32_bf16 v[88:91], a[104:107], a[56:59], v[88:91]
    v_mfma_f32_16x16x32_bf16 v[88:91], a[108:111], a[60:63], v[88:91]
    v_mfma_f32_16x16x32_bf16 v[92:95], a[124:127], a[60:63], v[92:95]
    v_mfma_f32_16x16x32_bf16 v[92:95], a[120:123], a[56:59], v[92:95]
    v_mfma_f32_16x16x32_bf16 v[92:95], a[116:119], a[52:55], v[92:95]
    v_mfma_f32_16x16x32_bf16 v[92:95], a[112:115], a[48:51], v[92:95]
    s_nop 7
    v_exp_f32 v80, v80
    v_exp_f32 v81, v81
    v_exp_f32 v82, v82
    v_exp_f32 v83, v83
    v_exp_f32 v84, v84
    v_exp_f32 v85, v85
    v_exp_f32 v86, v86
    v_exp_f32 v87, v87
    v_exp_f32 v88, v88
    v_exp_f32 v89, v89
    v_exp_f32 v90, v90
    v_exp_f32 v91, v91
    v_exp_f32 v92, v92
    v_exp_f32 v93, v93
    v_exp_f32 v94, v94
    v_exp_f32 v95, v95
    v_cvt_pk_bf16_f32 v80, v80, v81
    v_cvt_pk_bf16_f32 v81, v82, v83
    v_cvt_pk_bf16_f32 v82, v84, v85
    v_cvt_pk_bf16_f32 v83, v86, v87
    v_cvt_pk_bf16_f32 v84, v88, v89
    v_cvt_pk_bf16_f32 v85, v90, v91
    v_cvt_pk_bf16_f32 v86, v92, v93
    v_cvt_pk_bf16_f32 v87, v94, v95
    s_nop 1
    v_mfma_f32_16x16x32_bf16 v[224:227], a[128:131], v[80:83], v[224:227]
    v_mfma_f32_16x16x32_bf16 v[224:227], a[132:135], v[84:87], v[224:227]
    v_mfma_f32_16x16x32_bf16 v[228:231], a[136:139], v[80:83], v[228:231]
    v_mfma_f32_16x16x32_bf16 v[228:231], a[140:143], v[84:87], v[228:231]
    v_mfma_f32_16x16x32_bf16 v[232:235], a[144:147], v[80:83], v[232:235]
    v_mfma_f32_16x16x32_bf16 v[232:235], a[148:151], v[84:87], v[232:235]
    v_mfma_f32_16x16x32_bf16 v[236:239], a[152:155], v[80:83], v[236:239]
    v_mfma_f32_16x16x32_bf16 v[236:239], a[156:159], v[84:87], v[236:239]
    v_mfma_f32_16x16x32_bf16 v[240:243], a[160:163], v[80:83], v[240:243]
    v_mfma_f32_16x16x32_bf16 v[240:243], a[164:167], v[84:87], v[240:243]
    v_mfma_f32_16x16x32_bf16 v[244:247], a[168:171], v[80:83], v[244:247]
    v_mfma_f32_16x16x32_bf16 v[244:247], a[172:175], v[84:87], v[244:247]
    v_mfma_f32_16x16x32_bf16 v[248:251], a[176:179], v[80:83], v[248:251]
    v_mfma_f32_16x16x32_bf16 v[248:251], a[180:183], v[84:87], v[248:251]
    v_mfma_f32_16x16x32_bf16 v[252:255], a[184:187], v[80:83], v[252:255]
    v_mfma_f32_16x16x32_bf16 v[252:255], a[188:191], v[84:87], v[252:255]
    v_smfmac_f32_16x16x64_bf16 v[60:63], a[192:195], v[80:87], v26
    v_add_u32 v5, 256, v5
    v_add_u32 v7, 512, v7
    s_add_u32 s18, s18, 1
    s_cmp_lt_u32 s18, 32
    s_cbranch_scc1 Lm_fb
    s_nop 7
    v_add_f32 v48, v48, v49
    v_add_f32 v50, v50, v51
    s_nop 1
    v_permlane32_swap_b32 v48, v50
    v_add_f32 v49, v48, v50
    v_add_f32 v50, v48, v50
    s_nop 1
    v_permlane32_swap_b32 v49, v50
    v_rcp_f32 v48, v49
    s_nop 0
    v_mul_f32 v50, -v50, v48
    v_pk_fma_f32 v[128:129], v[128:129], v[48:49], v[50:51] op_sel:[0,0,0] op_sel_hi:[1,0,0]
    v_pk_fma_f32 v[132:133], v[132:133], v[48:49], v[50:51] op_sel:[0,0,0] op_sel_hi:[1,0,0]
    v_pk_fma_f32 v[136:137], v[136:137], v[48:49], v[50:51] op_sel:[0,0,0] op_sel_hi:[1,0,0]
    v_pk_fma_f32 v[140:141], v[140:141], v[48:49], v[50:51] op_sel:[0,0,0] op_sel_hi:[1,0,0]
    v_cvt_pk_bf16_f32 v96, v128, v132
    v_cvt_pk_bf16_f32 v97, v136, v140
    v_cvt_pk_bf16_f32 v98, v129, v133
    v_cvt_pk_bf16_f32 v99, v137, v141
    ds_write_b128 v8, v[96:99] offset:0
    v_pk_fma_f32 v[130:131], v[130:131], v[48:49], v[50:51] op_sel:[0,0,0] op_sel_hi:[1,0,0]
    v_pk_fma_f32 v[134:135], v[134:135], v[48:49], v[50:51] op_sel:[0,0,0] op_sel_hi:[1,0,0]
    v_pk_fma_f32 v[138:139], v[138:139], v[48:49], v[50:51] op_sel:[0,0,0] op_sel_hi:[1,0,0]
    v_pk_fma_f32 v[142:143], v[142:143], v[48:49], v[50:51] op_sel:[0,0,0] op_sel_hi:[1,0,0]
    v_cvt_pk_bf16_f32 v100, v130, v134
    v_cvt_pk_bf16_f32 v101, v138, v142
    v_cvt_pk_bf16_f32 v102, v131, v135
    v_cvt_pk_bf16_f32 v103, v139, v143
    ds_write_b128 v9, v[100:103] offset:0
    v_pk_fma_f32 v[144:145], v[144:145], v[48:49], v[50:51] op_sel:[0,0,0] op_sel_hi:[1,0,0]
    v_pk_fma_f32 v[148:149], v[148:149], v[48:49], v[50:51] op_sel:[0,0,0] op_sel_hi:[1,0,0]
    v_pk_fma_f32 v[152:153], v[152:153], v[48:49], v[50:51] op_sel:[0,0,0] op_sel_hi:[1,0,0]
    v_pk_fma_f32 v[156:157], v[156:157], v[48:49], v[50:51] op_sel:[0,0,0] op_sel_hi:[1,0,0]
    v_cvt_pk_bf16_f32 v104, v144, v148
    v_cvt_pk_bf16_f32 v105, v152, v156
    v_cvt_pk_bf16_f32 v106, v145, v149
    v_cvt_pk_bf16_f32 v107, v153, v157
    ds_write_b128 v10, v[104:107] offset:0
    v_pk_fma_f32 v[146:147], v[146:147], v[48:49], v[50:51] op_sel:[0,0,0] op_sel_hi:[1,0,0]
    v_pk_fma_f32 v[150:151], v[150:151], v[48:49], v[50:51] op_sel:[0,0,0] op_sel_hi:[1,0,0]
    v_pk_fma_f32 v[154:155], v[154:155], v[48:49], v[50:51] op_sel:[0,0,0] op_sel_hi:[1,0,0]
    v_pk_fma_f32 v[158:159], v[158:159], v[48:49], v[50:51] op_sel:[0,0,0] op_sel_hi:[1,0,0]
    v_cvt_pk_bf16_f32 v108, v146, v150
    v_cvt_pk_bf16_f32 v109, v154, v158
    v_cvt_pk_bf16_f32 v110, v147, v151
    v_cvt_pk_bf16_f32 v111, v155, v159
    ds_write_b128 v11, v[108:111] offset:0
    ds_read_b128 v[128:131], v16 offset:0
    ds_read_b128 v[132:135], v16 offset:1024
    ds_read_b128 v[136:139], v16 offset:2048
    ds_read_b128 v[140:143], v16 offset:3072
    s_waitcnt lgkmcnt(0)
    s_add_u32 s16, s32, 0
    buffer_store_dwordx4 v[128:131], v12, s[12:15], s16 offen offset:0 nt
    buffer_store_dwordx4 v[132:135], v13, s[12:15], s16 offen offset:1024 nt
    buffer_store_dwordx4 v[136:139], v14, s[12:15], s16 offen offset:2048 nt
    buffer_store_dwordx4 v[140:143], v15, s[12:15], s16 offen offset:3072 nt
    v_add_f32 v52, v52, v53
    v_add_f32 v54, v54, v55
    s_nop 1
    v_permlane32_swap_b32 v52, v54
    v_add_f32 v53, v52, v54
    v_add_f32 v54, v52, v54
    s_nop 1
    v_permlane32_swap_b32 v53, v54
    v_rcp_f32 v52, v53
    s_nop 0
    v_mul_f32 v54, -v54, v52
    v_pk_fma_f32 v[160:161], v[160:161], v[52:53], v[54:55] op_sel:[0,0,0] op_sel_hi:[1,0,0]
    v_pk_fma_f32 v[164:165], v[164:165], v[52:53], v[54:55] op_sel:[0,0,0] op_sel_hi:[1,0,0]
    v_pk_fma_f32 v[168:169], v[168:169], v[52:53], v[54:55] op_sel:[0,0,0] op_sel_hi:[1,0,0]
    v_pk_fma_f32 v[172:173], v[172:173], v[52:53], v[54:55] op_sel:[0,0,0] op_sel_hi:[1,0,0]
    v_cvt_pk_bf16_f32 v96, v160, v164
    v_cvt_pk_bf16_f32 v97, v168, v172
    v_cvt_pk_bf16_f32 v98, v161, v165
    v_cvt_pk_bf16_f32 v99, v169, v173
    ds_write_b128 v8, v[96:99] offset:4096
    v_pk_fma_f32 v[162:163], v[162:163], v[52:53], v[54:55] op_sel:[0,0,0] op_sel_hi:[1,0,0]
    v_pk_fma_f32 v[166:167], v[166:167], v[52:53], v[54:55] op_sel:[0,0,0] op_sel_hi:[1,0,0]
    v_pk_fma_f32 v[170:171], v[170:171], v[52:53], v[54:55] op_sel:[0,0,0] op_sel_hi:[1,0,0]
    v_pk_fma_f32 v[174:175], v[174:175], v[52:53], v[54:55] op_sel:[0,0,0] op_sel_hi:[1,0,0]
    v_cvt_pk_bf16_f32 v100, v162, v166
    v_cvt_pk_bf16_f32 v101, v170, v174
    v_cvt_pk_bf16_f32 v102, v163, v167
    v_cvt_pk_bf16_f32 v103, v171, v175
    ds_write_b128 v9, v[100:103] offset:4096
    v_pk_fma_f32 v[176:177], v[176:177], v[52:53], v[54:55] op_sel:[0,0,0] op_sel_hi:[1,0,0]
    v_pk_fma_f32 v[180:181], v[180:181], v[52:53], v[54:55] op_sel:[0,0,0] op_sel_hi:[1,0,0]
    v_pk_fma_f32 v[184:185], v[184:185], v[52:53], v[54:55] op_sel:[0,0,0] op_sel_hi:[1,0,0]
    v_pk_fma_f32 v[188:189], v[188:189], v[52:53], v[54:55] op_sel:[0,0,0] op_sel_hi:[1,0,0]
    v_cvt_pk_bf16_f32 v104, v176, v180
    v_cvt_pk_bf16_f32 v105, v184, v188
    v_cvt_pk_bf16_f32 v106, v177, v181
    v_cvt_pk_bf16_f32 v107, v185, v189
    ds_write_b128 v10, v[104:107] offset:4096
    v_pk_fma_f32 v[178:179], v[178:179], v[52:53], v[54:55] op_sel:[0,0,0] op_sel_hi:[1,0,0]
    v_pk_fma_f32 v[182:183], v[182:183], v[52:53], v[54:55] op_sel:[0,0,0] op_sel_hi:[1,0,0]
    v_pk_fma_f32 v[186:187], v[186:187], v[52:53], v[54:55] op_sel:[0,0,0] op_sel_hi:[1,0,0]
    v_pk_fma_f32 v[190:191], v[190:191], v[52:53], v[54:55] op_sel:[0,0,0] op_sel_hi:[1,0,0]
    v_cvt_pk_bf16_f32 v108, v178, v182
    v_cvt_pk_bf16_f32 v109, v186, v190
    v_cvt_pk_bf16_f32 v110, v179, v183
    v_cvt_pk_bf16_f32 v111, v187, v191
    ds_write_b128 v11, v[108:111] offset:4096
    ds_read_b128 v[160:163], v16 offset:4096
    ds_read_b128 v[164:167], v16 offset:5120
    ds_read_b128 v[168:171], v16 offset:6144
    ds_read_b128 v[172:175], v16 offset:7168
    s_waitcnt lgkmcnt(0)
    s_add_u32 s16, s32, 4096
    buffer_store_dwordx4 v[160:163], v12, s[12:15], s16 offen offset:0 nt
    buffer_store_dwordx4 v[164:167], v13, s[12:15], s16 offen offset:1024 nt
    buffer_store_dwordx4 v[168:171], v14, s[12:15], s16 offen offset:2048 nt
    buffer_store_dwordx4 v[172:175], v15, s[12:15], s16 offen offset:3072 nt
    v_add_f32 v56, v56, v57
    v_add_f32 v58, v58, v59
    s_nop 1
    v_permlane32_swap_b32 v56, v58
    v_add_f32 v57, v56, v58
    v_add_f32 v58, v56, v58
    s_nop 1
    v_permlane32_swap_b32 v57, v58
    v_rcp_f32 v56, v57
    s_nop 0
    v_mul_f32 v58, -v58, v56
    v_pk_fma_f32 v[192:193], v[192:193], v[56:57], v[58:59] op_sel:[0,0,0] op_sel_hi:[1,0,0]
    v_pk_fma_f32 v[196:197], v[196:197], v[56:57], v[58:59] op_sel:[0,0,0] op_sel_hi:[1,0,0]
    v_pk_fma_f32 v[200:201], v[200:201], v[56:57], v[58:59] op_sel:[0,0,0] op_sel_hi:[1,0,0]
    v_pk_fma_f32 v[204:205], v[204:205], v[56:57], v[58:59] op_sel:[0,0,0] op_sel_hi:[1,0,0]
    v_cvt_pk_bf16_f32 v96, v192, v196
    v_cvt_pk_bf16_f32 v97, v200, v204
    v_cvt_pk_bf16_f32 v98, v193, v197
    v_cvt_pk_bf16_f32 v99, v201, v205
    ds_write_b128 v8, v[96:99] offset:0
    v_pk_fma_f32 v[194:195], v[194:195], v[56:57], v[58:59] op_sel:[0,0,0] op_sel_hi:[1,0,0]
    v_pk_fma_f32 v[198:199], v[198:199], v[56:57], v[58:59] op_sel:[0,0,0] op_sel_hi:[1,0,0]
    v_pk_fma_f32 v[202:203], v[202:203], v[56:57], v[58:59] op_sel:[0,0,0] op_sel_hi:[1,0,0]
    v_pk_fma_f32 v[206:207], v[206:207], v[56:57], v[58:59] op_sel:[0,0,0] op_sel_hi:[1,0,0]
    v_cvt_pk_bf16_f32 v100, v194, v198
    v_cvt_pk_bf16_f32 v101, v202, v206
    v_cvt_pk_bf16_f32 v102, v195, v199
    v_cvt_pk_bf16_f32 v103, v203, v207
    ds_write_b128 v9, v[100:103] offset:0
    v_pk_fma_f32 v[208:209], v[208:209], v[56:57], v[58:59] op_sel:[0,0,0] op_sel_hi:[1,0,0]
    v_pk_fma_f32 v[212:213], v[212:213], v[56:57], v[58:59] op_sel:[0,0,0] op_sel_hi:[1,0,0]
    v_pk_fma_f32 v[216:217], v[216:217], v[56:57], v[58:59] op_sel:[0,0,0] op_sel_hi:[1,0,0]
    v_pk_fma_f32 v[220:221], v[220:221], v[56:57], v[58:59] op_sel:[0,0,0] op_sel_hi:[1,0,0]
    v_cvt_pk_bf16_f32 v104, v208, v212
    v_cvt_pk_bf16_f32 v105, v216, v220
    v_cvt_pk_bf16_f32 v106, v209, v213
    v_cvt_pk_bf16_f32 v107, v217, v221
    ds_write_b128 v10, v[104:107] offset:0
    v_pk_fma_f32 v[210:211], v[210:211], v[56:57], v[58:59] op_sel:[0,0,0] op_sel_hi:[1,0,0]
    v_pk_fma_f32 v[214:215], v[214:215], v[56:57], v[58:59] op_sel:[0,0,0] op_sel_hi:[1,0,0]
    v_pk_fma_f32 v[218:219], v[218:219], v[56:57], v[58:59] op_sel:[0,0,0] op_sel_hi:[1,0,0]
    v_pk_fma_f32 v[222:223], v[222:223], v[56:57], v[58:59] op_sel:[0,0,0] op_sel_hi:[1,0,0]
    v_cvt_pk_bf16_f32 v108, v210, v214
    v_cvt_pk_bf16_f32 v109, v218, v222
    v_cvt_pk_bf16_f32 v110, v211, v215
    v_cvt_pk_bf16_f32 v111, v219, v223
    ds_write_b128 v11, v[108:111] offset:0
    ds_read_b128 v[192:195], v16 offset:0
    ds_read_b128 v[196:199], v16 offset:1024
    ds_read_b128 v[200:203], v16 offset:2048
    ds_read_b128 v[204:207], v16 offset:3072
    s_waitcnt lgkmcnt(0)
    s_add_u32 s16, s32, 8192
    buffer_store_dwordx4 v[192:195], v12, s[12:15], s16 offen offset:0 nt
    buffer_store_dwordx4 v[196:199], v13, s[12:15], s16 offen offset:1024 nt
    buffer_store_dwordx4 v[200:203], v14, s[12:15], s16 offen offset:2048 nt
    buffer_store_dwordx4 v[204:207], v15, s[12:15], s16 offen offset:3072 nt
    v_add_f32 v60, v60, v61
    v_add_f32 v62, v62, v63
    s_nop 1
    v_permlane32_swap_b32 v60, v62
    v_add_f32 v61, v60, v62
    v_add_f32 v62, v60, v62
    s_nop 1
    v_permlane32_swap_b32 v61, v62
    v_rcp_f32 v60, v61
    s_nop 0
    v_mul_f32 v62, -v62, v60
    v_pk_fma_f32 v[224:225], v[224:225], v[60:61], v[62:63] op_sel:[0,0,0] op_sel_hi:[1,0,0]
    v_pk_fma_f32 v[228:229], v[228:229], v[60:61], v[62:63] op_sel:[0,0,0] op_sel_hi:[1,0,0]
    v_pk_fma_f32 v[232:233], v[232:233], v[60:61], v[62:63] op_sel:[0,0,0] op_sel_hi:[1,0,0]
    v_pk_fma_f32 v[236:237], v[236:237], v[60:61], v[62:63] op_sel:[0,0,0] op_sel_hi:[1,0,0]
    v_cvt_pk_bf16_f32 v96, v224, v228
    v_cvt_pk_bf16_f32 v97, v232, v236
    v_cvt_pk_bf16_f32 v98, v225, v229
    v_cvt_pk_bf16_f32 v99, v233, v237
    ds_write_b128 v8, v[96:99] offset:4096
    v_pk_fma_f32 v[226:227], v[226:227], v[60:61], v[62:63] op_sel:[0,0,0] op_sel_hi:[1,0,0]
    v_pk_fma_f32 v[230:231], v[230:231], v[60:61], v[62:63] op_sel:[0,0,0] op_sel_hi:[1,0,0]
    v_pk_fma_f32 v[234:235], v[234:235], v[60:61], v[62:63] op_sel:[0,0,0] op_sel_hi:[1,0,0]
    v_pk_fma_f32 v[238:239], v[238:239], v[60:61], v[62:63] op_sel:[0,0,0] op_sel_hi:[1,0,0]
    v_cvt_pk_bf16_f32 v100, v226, v230
    v_cvt_pk_bf16_f32 v101, v234, v238
    v_cvt_pk_bf16_f32 v102, v227, v231
    v_cvt_pk_bf16_f32 v103, v235, v239
    ds_write_b128 v9, v[100:103] offset:4096
    v_pk_fma_f32 v[240:241], v[240:241], v[60:61], v[62:63] op_sel:[0,0,0] op_sel_hi:[1,0,0]
    v_pk_fma_f32 v[244:245], v[244:245], v[60:61], v[62:63] op_sel:[0,0,0] op_sel_hi:[1,0,0]
    v_pk_fma_f32 v[248:249], v[248:249], v[60:61], v[62:63] op_sel:[0,0,0] op_sel_hi:[1,0,0]
    v_pk_fma_f32 v[252:253], v[252:253], v[60:61], v[62:63] op_sel:[0,0,0] op_sel_hi:[1,0,0]
    v_cvt_pk_bf16_f32 v104, v240, v244
    v_cvt_pk_bf16_f32 v105, v248, v252
    v_cvt_pk_bf16_f32 v106, v241, v245
    v_cvt_pk_bf16_f32 v107, v249, v253
    ds_write_b128 v10, v[104:107] offset:4096
    v_pk_fma_f32 v[242:243], v[242:243], v[60:61], v[62:63] op_sel:[0,0,0] op_sel_hi:[1,0,0]
    v_pk_fma_f32 v[246:247], v[246:247], v[60:61], v[62:63] op_sel:[0,0,0] op_sel_hi:[1,0,0]
    v_pk_fma_f32 v[250:251], v[250:251], v[60:61], v[62:63] op_sel:[0,0,0] op_sel_hi:[1,0,0]
    v_pk_fma_f32 v[254:255], v[254:255], v[60:61], v[62:63] op_sel:[0,0,0] op_sel_hi:[1,0,0]
    v_cvt_pk_bf16_f32 v108, v242, v246
    v_cvt_pk_bf16_f32 v109, v250, v254
    v_cvt_pk_bf16_f32 v110, v243, v247
    v_cvt_pk_bf16_f32 v111, v251, v255
    ds_write_b128 v11, v[108:111] offset:4096
    ds_read_b128 v[224:227], v16 offset:4096
    ds_read_b128 v[228:231], v16 offset:5120
    ds_read_b128 v[232:235], v16 offset:6144
    ds_read_b128 v[236:239], v16 offset:7168
    s_waitcnt lgkmcnt(0)
    s_add_u32 s16, s32, 12288
    buffer_store_dwordx4 v[224:227], v12, s[12:15], s16 offen offset:0 nt
    buffer_store_dwordx4 v[228:231], v13, s[12:15], s16 offen offset:1024 nt
    buffer_store_dwordx4 v[232:235], v14, s[12:15], s16 offen offset:2048 nt
    buffer_store_dwordx4 v[236:239], v15, s[12:15], s16 offen offset:3072 nt
    s_branch Lm_vote
.section .rodata,"a"
.p2align 6
.amdhsa_kernel standalone__kv_cache_quant_int4_int2_kv_with_per_channel_or_per_token_scales__prompt_kernel
  .amdhsa_next_free_vgpr 464
  .amdhsa_next_free_sgpr 102
  .amdhsa_accum_offset 256
  .amdhsa_group_segment_fixed_size 0
  .amdhsa_kernarg_size 80
  .amdhsa_user_sgpr_count 2
  .amdhsa_user_sgpr_kernarg_segment_ptr 1
  .amdhsa_system_sgpr_workgroup_id_x 1
  .amdhsa_float_denorm_mode_32 3
.end_amdhsa_kernel
```
